```python
import torch

def _softmax(x, axis=-1):
    return torch.softmax(x, dim=axis)
def _gelu(x):
    return torch.nn.functional.gelu(x, approximate="tanh")
def _silu(x):
    return torch.nn.functional.silu(x)
def _sigmoid(x):
    return torch.sigmoid(x)
def _layernorm(x, axis=-1, eps=1e-5):
    m = x.mean(dim=axis, keepdim=True)
    v = x.var(dim=axis, keepdim=True, unbiased=False)
    return (x - m) / torch.sqrt(v + eps)
def _scatter_add(tgt, idx, src, axis=0):
    return tgt.clone().index_add_(axis, idx, src)
def _segment_sum(src, seg, n):
    out = torch.zeros((n,) + src.shape[1:], dtype=src.dtype)
    return out.index_add_(0, seg, src)
def _pad(x, pw):
    flat = tuple(v for pair in reversed(pw) for v in pair)
    return torch.nn.functional.pad(x, flat)

kernel_name = 'sequential_preLN__sliding_block_cached__dense_activation_silu__decode'

def setup_inputs():

    _w = (lambda a: (lambda t: t.to(torch.bfloat16) if t.is_floating_point() else t)(torch.as_tensor(a)))
    def _A_setup():
        B, Sq, D = 1, 1, 576
        Hq, Hkv, Sk, Dh = 32, 16, 8192, 128
        assert Hq % Hkv == 0, (Hq, Hkv)
        return {
            "x": _w((lambda *s: torch.randn(*s, dtype=torch.bfloat16) * 0.05)(B, Sq, D)),
            "k_cache": _w((lambda *s: torch.randn(*s, dtype=torch.bfloat16) * 3.2)(B, Hkv, Sk, Dh)),
            "v_cache": _w((lambda *s: torch.randn(*s, dtype=torch.bfloat16) * 0.8)(B, Hkv, Sk, Dh)),
            "wq": _w((lambda *s: torch.randn(*s, dtype=torch.bfloat16) * 3.2)(D, Hq * Dh) * (D ** -0.5)),
            "wo": _w((lambda *s: torch.randn(*s, dtype=torch.bfloat16) * 0.8)(Hq * Dh, D) * ((Hq * Dh) ** -0.5)),
        }
    _A_in = _A_setup()

    def _B_setup():
        B, S, D, F = 1, 1, 576, 4608
        return {
            "x": _w((lambda *s: torch.randn(*s, dtype=torch.bfloat16) * 0.05)(B, S, D)),
            "w1": _w((lambda *s: torch.randn(*s, dtype=torch.bfloat16) * 3.2)(D, F) * (D ** -0.5)),
            "w2": _w((lambda *s: torch.randn(*s, dtype=torch.bfloat16) * 0.4)(F, D) * (F ** -0.5)),
        }
    _B_in = _B_setup()

    return {
        "A_x": _A_in["x"],
        "A_k_cache": _A_in["k_cache"],
        "A_v_cache": _A_in["v_cache"],
        "A_wq": _A_in["wq"],
        "A_wo": _A_in["wo"],
        "B_x": _B_in["x"],
        "B_w1": _B_in["w1"],
        "B_w2": _B_in["w2"],
    }

def reference(A_x, A_k_cache, A_v_cache, A_wq, A_wo, B_x, B_w1, B_w2):
    def _A_ref(x, k_cache, v_cache, wq, wo):
        B, Sq, D = x.shape
        Hq, Dh = 32, 128
        Hkv, Sk = k_cache.shape[1], k_cache.shape[2]
        W = min(4096, max(256, Sk // 4))
        rep = Hq // Hkv
        q = (lambda x, *d: x.permute(*d))((x @ wq).reshape(B, Sq, Hq, Dh), 0, 2, 1, 3)
        k = (lambda x, n, axis: torch.repeat_interleave(x, n, dim=axis))(k_cache[:, :, Sk - W:, :], rep, axis=1)
        v = (lambda x, n, axis: torch.repeat_interleave(x, n, dim=axis))(v_cache[:, :, Sk - W:, :], rep, axis=1)
        scores = torch.einsum("bhqd,bhkd->bhqk", q, k) * (Dh ** -0.5)
        p = _softmax(scores, axis=-1)
        o = torch.einsum("bhqk,bhkd->bhqd", p, v)
        return (lambda x, *d: x.permute(*d))(o, 0, 2, 1, 3).reshape(B, Sq, Hq * Dh) @ wo

    def _B_ref(x, w1, w2):
        h = torch.einsum("bsd,df->bsf", x, w1)
        h = _silu(h)
        out = torch.einsum("bsf,fd->bsd", h, w2)
        return out

    x = A_x
    h = x + _A_ref(_layernorm(x, axis=-1), A_k_cache, A_v_cache, A_wq, A_wo)
    h2 = h + _B_ref(_layernorm(h, axis=-1), B_w1, B_w2)
    return h2
```

```asm
; @launch grid=(256,1,1) block=(576,1,1) lds=9472
.amdgcn_target "amdgcn-amd-amdhsa--gfx950"
.text
.globl sequential_preLN__sliding_block_cached__dense_activation_silu__decode_kernel
.p2align 8
.type sequential_preLN__sliding_block_cached__dense_activation_silu__decode_kernel,@function
sequential_preLN__sliding_block_cached__dense_activation_silu__decode_kernel:
    s_cmp_ge_u32 s2, 256
    s_cbranch_scc1 L_end
    s_load_dwordx2 s[68:69], s[0:1], 24
    s_load_dwordx2 s[60:61], s[0:1], 0
    s_load_dwordx2 s[44:45], s[0:1], 8
    s_load_dwordx2 s[48:49], s[0:1], 16
    s_load_dwordx2 s[40:41], s[0:1], 80
    s_load_dwordx2 s[72:73], s[0:1], 32
    s_load_dwordx2 s[52:53], s[0:1], 48
    s_load_dwordx2 s[56:57], s[0:1], 56
    s_load_dwordx2 s[64:65], s[0:1], 64
    v_lshrrev_b32 v16, 6, v0
    v_and_b32 v1, 63, v0
    s_and_b32 s4, s2, 7
    s_bfe_u32 s5, s2, 0x40003
    v_readfirstlane_b32 s3, v16
    v_and_b32 v2, 15, v0
    v_bfe_u32 v3, v0, 4, 2
    s_mov_b32 s46, 33554432
    s_mov_b32 s47, 0x20000
    s_mov_b32 s50, 33554432
    s_mov_b32 s51, 0x20000
    s_mov_b32 s70, 4718592
    s_mov_b32 s71, 0x20000
    s_mov_b32 s62, 1152
    s_mov_b32 s63, 0x20000
    s_mov_b32 s42, 268435456
    s_mov_b32 s43, 0x20000
    s_mov_b32 s54, 5308416
    s_mov_b32 s55, 0x20000
    s_mov_b32 s58, 5308416
    s_mov_b32 s59, 0x20000
    s_mov_b32 s66, 1152
    s_mov_b32 s67, 0x20000
    s_mov_b32 s74, 4718592
    s_mov_b32 s75, 0x20000
    s_mov_b32 s78, 0xffff0000
    s_mov_b32 s81, 0x3f803f80
    s_mov_b32 s79, 0xffffff00
    s_mov_b32 s82, 0xaaaaaaaa
    s_mov_b32 s83, 0xaaaaaaaa
    s_bitcmp1_b32 s2, 7
    s_cbranch_scc0 L_nonA
    s_cmp_eq_u32 s3, 8
    s_cbranch_scc1 L_AC
    s_lshr_b32 s6, s5, 3
    s_lshl_b32 s7, s4, 1
    s_add_u32 s6, s6, s7
    s_lshl_b32 s6, s6, 21
    s_and_b32 s7, s5, 7
    s_lshl_b32 s7, s7, 16
    s_add_u32 s6, s6, s7
    s_lshl_b32 s7, s3, 13
    s_add_u32 s6, s6, s7
    s_add_u32 s8, s6, 1572864
    s_add_u32 s9, s8, 4096
    v_lshrrev_b32 v16, 1, v2
    v_lshlrev_b32 v16, 10, v16
    v_lshl_add_u32 v16, v3, 5, v16
    v_and_b32 v18, 1, v1
    v_lshl_add_u32 v16, v18, 4, v16
    v_lshlrev_b32 v17, 4, v1
    s_waitcnt lgkmcnt(0)
    buffer_load_dwordx4 v[32:35], v16, s[44:47], s8 offen offset:0 nt
    buffer_load_dwordx4 v[36:39], v16, s[44:47], s8 offen offset:128 nt
    buffer_load_dwordx4 v[40:43], v16, s[44:47], s8 offen offset:256 nt
    s_load_dword s77, s[40:41], 1044480
    v_bfe_u32 v19, v1, 1, 1
    v_lshlrev_b32 v19, 4, v19
    v_mov_b32 v20, 0xffff
    v_lshlrev_b32 v19, v19, v20
    v_lshrrev_b32 v20, 2, v2
    v_cmp_eq_u32 vcc, 0, v20
    s_nop 1
    v_cndmask_b32 v4, 0, v19, vcc
    v_cmp_eq_u32 vcc, 1, v20
    s_nop 1
    v_cndmask_b32 v5, 0, v19, vcc
    v_cmp_eq_u32 vcc, 2, v20
    s_nop 1
    v_cndmask_b32 v6, 0, v19, vcc
    v_cmp_eq_u32 vcc, 3, v20
    s_nop 1
    v_cndmask_b32 v7, 0, v19, vcc
    v_bfe_u32 v19, v1, 1, 1
    v_lshlrev_b32 v19, 8, v19
    v_lshl_add_u32 v19, v18, 4, v19
    v_lshl_add_u32 v19, v3, 5, v19
    s_lshl_b32 s6, s3, 3
    v_lshl_add_u32 v24, v18, 6, s6
    s_mul_i32 s6, s3, 1040
    v_add_u32 v25, s6, v17
    v_and_b32 v26, 14, v1
    v_lshlrev_b32 v26, 2, v26
    v_lshl_add_u32 v26, v18, 6, v26
    v_and_b32 v27, 7, v1
    v_mul_u32_u24 v27, 1040, v27
    v_lshrrev_b32 v28, 3, v1
    v_lshl_add_u32 v27, v28, 4, v27
    s_lshl_b32 s6, s3, 7
    v_add_u32 v27, s6, v27
    v_and_b32 v28, 1, v28
    v_lshlrev_b32 v28, 9, v28
    v_lshl_add_u32 v28, v3, 4, v28
    s_lshl_b32 s14, s4, 4
    s_add_u32 s14, s14, s5
    s_lshl_b32 s14, s14, 10
    s_lshl_b32 s6, s3, 6
    s_add_u32 s14, s14, s6
    s_add_u32 s14, s14, 65536
    s_xor_b32 s15, s14, 524288
    s_waitcnt vmcnt(2)
    buffer_load_dwordx4 v[44:47], v16, s[44:47], s8 offen offset:384 nt
    s_waitcnt vmcnt(2)
    buffer_load_dwordx4 v[48:51], v16, s[44:47], s8 offen offset:512 nt
    buffer_load_dwordx4 v[52:55], v16, s[44:47], s8 offen offset:640 nt
    s_waitcnt vmcnt(3)
    buffer_load_dwordx4 v[56:59], v16, s[44:47], s8 offen offset:768 nt
    buffer_load_dwordx4 v[60:63], v16, s[44:47], s8 offen offset:896 nt
    s_waitcnt vmcnt(4)
    buffer_load_dwordx4 v[64:67], v17, s[48:51], s8 offen offset:0 nt
    buffer_load_dwordx4 v[68:71], v17, s[48:51], s8 offen offset:1024 nt
    s_waitcnt vmcnt(5)
    buffer_load_dwordx4 v[72:75], v17, s[48:51], s8 offen offset:2048 nt
    buffer_load_dwordx4 v[76:79], v17, s[48:51], s8 offen offset:3072 nt
    s_waitcnt vmcnt(6)
    buffer_load_dwordx4 v[80:83], v17, s[48:51], s9 offen offset:0 nt
    buffer_load_dwordx4 v[84:87], v17, s[48:51], s9 offen offset:1024 nt
    s_waitcnt vmcnt(7)
    buffer_load_dwordx4 v[88:91], v17, s[48:51], s9 offen offset:2048 nt
    buffer_load_dwordx4 v[92:95], v17, s[48:51], s9 offen offset:3072 nt
    s_waitcnt lgkmcnt(0)
    s_mul_i32 s76, s77, 1664525
    s_add_u32 s76, s76, 1013904223
    s_bfe_u32 s6, s76, 0x80000
    v_mov_b32 v8, s6
    s_bfe_u32 s6, s76, 0x80008
    v_mov_b32 v9, s6
    s_bfe_u32 s6, s76, 0x80010
    v_mov_b32 v10, s6
    s_bfe_u32 s6, s76, 0x80018
    v_mov_b32 v11, s6
    s_barrier
    ds_read_b128 v[96:99], v19 offset:0
    ds_read_b128 v[100:103], v19 offset:128
    s_waitcnt vmcnt(8)
    s_waitcnt lgkmcnt(1)
    v_mfma_f32_16x16x32_bf16 v[104:107], v[96:99], v[32:35], 0
    v_mfma_f32_16x16x32_bf16 v[108:111], v[96:99], v[40:43], 0
    v_mfma_f32_16x16x32_bf16 v[112:115], v[96:99], v[48:51], 0
    v_mfma_f32_16x16x32_bf16 v[116:119], v[96:99], v[56:59], 0
    s_waitcnt lgkmcnt(0)
    v_mfma_f32_16x16x32_bf16 v[104:107], v[100:103], v[36:39], v[104:107]
    v_mfma_f32_16x16x32_bf16 v[108:111], v[100:103], v[44:47], v[108:111]
    v_mfma_f32_16x16x32_bf16 v[112:115], v[100:103], v[52:55], v[112:115]
    v_mfma_f32_16x16x32_bf16 v[116:119], v[100:103], v[60:63], v[116:119]
    s_nop 4
    v_cndmask_b32 v106, v106, v105, s[82:83]
    v_cndmask_b32 v104, v104, v107, s[82:83]
    v_cndmask_b32 v110, v110, v109, s[82:83]
    v_cndmask_b32 v108, v108, v111, s[82:83]
    v_cndmask_b32 v114, v114, v113, s[82:83]
    v_cndmask_b32 v112, v112, v115, s[82:83]
    v_cndmask_b32 v118, v118, v117, s[82:83]
    v_cndmask_b32 v116, v116, v119, s[82:83]
    v_add_f32_dpp v132, v106, v104 quad_perm:[1,0,3,2] row_mask:0x1 bank_mask:0xf
    s_nop 1
    v_add_f32_dpp v132, v110, v108 quad_perm:[1,0,3,2] row_mask:0x2 bank_mask:0xf
    s_nop 1
    v_add_f32_dpp v132, v114, v112 quad_perm:[1,0,3,2] row_mask:0x4 bank_mask:0xf
    s_nop 1
    v_add_f32_dpp v132, v118, v116 quad_perm:[1,0,3,2] row_mask:0x8 bank_mask:0xf
    v_cvt_pk_bf16_f32 v132, v132, v132
    v_and_b32 v132, s78, v132
    v_mul_f32 v132, 0x3db504f3, v132
    v_cvt_pk_bf16_f32 v132, v132, v132
    v_and_b32 v132, s78, v132
    s_nop 1
    v_max_f32_dpp v130, v132, v132 quad_perm:[2,3,0,1] row_mask:0xf bank_mask:0xf
    s_nop 1
    v_max_f32_dpp v130, v130, v130 row_ror:4 row_mask:0xf bank_mask:0xf
    s_nop 1
    v_max_f32_dpp v130, v130, v130 row_ror:8 row_mask:0xf bank_mask:0xf
    v_mov_b32 v128, v130
    s_nop 1
    v_permlane32_swap_b32 v130, v128
    v_max_f32 v130, v130, v128
    v_mov_b32 v128, v130
    s_nop 1
    v_permlane16_swap_b32 v130, v128
    v_max_f32 v130, v130, v128
    v_sub_f32 v132, v132, v130
    v_mul_f32 v132, 0x3fb8aa3b, v132
    v_exp_f32 v131, v132
    s_nop 0
    v_cvt_pk_bf16_f32 v132, v131, v131
    s_nop 1
    v_mov_b32_dpp v133, v132 row_ror:4 row_mask:0xf bank_mask:0xf
    v_mov_b32_dpp v134, v132 row_ror:8 row_mask:0xf bank_mask:0xf
    v_mov_b32_dpp v135, v132 row_ror:12 row_mask:0xf bank_mask:0xf
    v_add_f32_dpp v131, v131, v131 quad_perm:[2,3,0,1] row_mask:0xf bank_mask:0xf
    s_nop 1
    v_add_f32_dpp v131, v131, v131 row_ror:4 row_mask:0xf bank_mask:0xf
    s_nop 1
    v_add_f32_dpp v131, v131, v131 row_ror:8 row_mask:0xf bank_mask:0xf
    v_and_b32_dpp v32, v132, v4 quad_perm:[0,1,0,1] row_mask:0xf bank_mask:0xf
    v_and_b32_dpp v33, v133, v5 quad_perm:[0,1,0,1] row_mask:0xf bank_mask:0xf
    v_and_b32_dpp v34, v134, v6 quad_perm:[0,1,0,1] row_mask:0xf bank_mask:0xf
    v_and_b32_dpp v35, v135, v7 quad_perm:[0,1,0,1] row_mask:0xf bank_mask:0xf
    v_mov_b32 v128, v131
    s_nop 1
    v_permlane32_swap_b32 v131, v128
    v_add_f32 v131, v131, v128
    v_mov_b32 v128, v131
    s_nop 1
    v_permlane16_swap_b32 v131, v128
    v_add_f32 v131, v131, v128
    s_mov_b64 exec, 3
    ds_write_b64 v24, v[130:131] offset:768
    s_mov_b64 exec, -1
    v_and_b32_dpp v36, v132, v4 quad_perm:[2,3,2,3] row_mask:0xf bank_mask:0xf
    v_and_b32_dpp v37, v133, v5 quad_perm:[2,3,2,3] row_mask:0xf bank_mask:0xf
    v_and_b32_dpp v38, v134, v6 quad_perm:[2,3,2,3] row_mask:0xf bank_mask:0xf
    v_and_b32_dpp v39, v135, v7 quad_perm:[2,3,2,3] row_mask:0xf bank_mask:0xf
    v_and_b32_dpp v40, v135, v4 quad_perm:[0,1,0,1] row_mask:0xf bank_mask:0xf
    v_and_b32_dpp v41, v132, v5 quad_perm:[0,1,0,1] row_mask:0xf bank_mask:0xf
    v_and_b32_dpp v42, v133, v6 quad_perm:[0,1,0,1] row_mask:0xf bank_mask:0xf
    v_and_b32_dpp v43, v134, v7 quad_perm:[0,1,0,1] row_mask:0xf bank_mask:0xf
    v_and_b32_dpp v44, v135, v4 quad_perm:[2,3,2,3] row_mask:0xf bank_mask:0xf
    v_and_b32_dpp v45, v132, v5 quad_perm:[2,3,2,3] row_mask:0xf bank_mask:0xf
    v_and_b32_dpp v46, v133, v6 quad_perm:[2,3,2,3] row_mask:0xf bank_mask:0xf
    v_and_b32_dpp v47, v134, v7 quad_perm:[2,3,2,3] row_mask:0xf bank_mask:0xf
    s_waitcnt lgkmcnt(0)
    s_barrier
    ds_read_b32 v29, v26 offset:768
    v_mov_b32 v30, v130
    v_and_b32_dpp v48, v134, v4 quad_perm:[0,1,0,1] row_mask:0xf bank_mask:0xf
    v_and_b32_dpp v49, v135, v5 quad_perm:[0,1,0,1] row_mask:0xf bank_mask:0xf
    v_and_b32_dpp v50, v132, v6 quad_perm:[0,1,0,1] row_mask:0xf bank_mask:0xf
    v_and_b32_dpp v51, v133, v7 quad_perm:[0,1,0,1] row_mask:0xf bank_mask:0xf
    v_and_b32_dpp v52, v134, v4 quad_perm:[2,3,2,3] row_mask:0xf bank_mask:0xf
    v_and_b32_dpp v53, v135, v5 quad_perm:[2,3,2,3] row_mask:0xf bank_mask:0xf
    v_and_b32_dpp v54, v132, v6 quad_perm:[2,3,2,3] row_mask:0xf bank_mask:0xf
    v_and_b32_dpp v55, v133, v7 quad_perm:[2,3,2,3] row_mask:0xf bank_mask:0xf
    v_and_b32_dpp v56, v133, v4 quad_perm:[0,1,0,1] row_mask:0xf bank_mask:0xf
    v_and_b32_dpp v57, v134, v5 quad_perm:[0,1,0,1] row_mask:0xf bank_mask:0xf
    v_and_b32_dpp v58, v135, v6 quad_perm:[0,1,0,1] row_mask:0xf bank_mask:0xf
    v_and_b32_dpp v59, v132, v7 quad_perm:[0,1,0,1] row_mask:0xf bank_mask:0xf
    v_and_b32_dpp v60, v133, v4 quad_perm:[2,3,2,3] row_mask:0xf bank_mask:0xf
    v_and_b32_dpp v61, v134, v5 quad_perm:[2,3,2,3] row_mask:0xf bank_mask:0xf
    v_and_b32_dpp v62, v135, v6 quad_perm:[2,3,2,3] row_mask:0xf bank_mask:0xf
    v_and_b32_dpp v63, v132, v7 quad_perm:[2,3,2,3] row_mask:0xf bank_mask:0xf
    s_waitcnt vmcnt(7)
    v_mfma_f32_16x16x32_bf16 v[128:131], v[64:67], v[32:35], 0
    s_waitcnt lgkmcnt(0)
    s_waitcnt vmcnt(6)
    v_mfma_f32_16x16x32_bf16 v[128:131], v[68:71], v[36:39], v[128:131]
    v_max_f32_dpp v29, v29, v29 quad_perm:[2,3,0,1] row_mask:0xf bank_mask:0xf
    s_waitcnt vmcnt(5)
    v_mfma_f32_16x16x32_bf16 v[128:131], v[72:75], v[40:43], v[128:131]
    v_max_f32_dpp v29, v29, v29 row_ror:4 row_mask:0xf bank_mask:0xf
    s_waitcnt vmcnt(4)
    v_mfma_f32_16x16x32_bf16 v[128:131], v[76:79], v[44:47], v[128:131]
    v_max_f32_dpp v29, v29, v29 row_ror:8 row_mask:0xf bank_mask:0xf
    s_waitcnt vmcnt(3)
    v_mfma_f32_16x16x32_bf16 v[128:131], v[80:83], v[48:51], v[128:131]
    v_sub_f32 v30, v30, v29
    s_waitcnt vmcnt(2)
    v_mfma_f32_16x16x32_bf16 v[128:131], v[84:87], v[52:55], v[128:131]
    v_mul_f32 v30, 0x3fb8aa3b, v30
    s_waitcnt vmcnt(1)
    v_mfma_f32_16x16x32_bf16 v[128:131], v[88:91], v[56:59], v[128:131]
    v_exp_f32 v30, v30
    s_waitcnt vmcnt(0)
    v_mfma_f32_16x16x32_bf16 v[128:131], v[92:95], v[60:63], v[128:131]
    s_nop 7
    v_pk_mul_f32 v[128:129], v[128:129], v[30:31] op_sel:[0,0] op_sel_hi:[1,0]
    v_pk_mul_f32 v[130:131], v[130:131], v[30:31] op_sel:[0,0] op_sel_hi:[1,0]
    ds_write_b128 v25, v[128:131] offset:1024
    s_waitcnt lgkmcnt(0)
    s_barrier
    ds_read_b128 v[96:99], v27 offset:1024
    s_waitcnt lgkmcnt(0)
    v_add_f32_dpp v96, v96, v96 quad_perm:[1,0,3,2] row_mask:0xf bank_mask:0xf
    v_add_f32_dpp v97, v97, v97 quad_perm:[1,0,3,2] row_mask:0xf bank_mask:0xf
    v_add_f32_dpp v98, v98, v98 quad_perm:[1,0,3,2] row_mask:0xf bank_mask:0xf
    v_add_f32_dpp v99, v99, v99 quad_perm:[1,0,3,2] row_mask:0xf bank_mask:0xf
    v_add_f32_dpp v96, v96, v96 quad_perm:[2,3,0,1] row_mask:0xf bank_mask:0xf
    v_add_f32_dpp v97, v97, v97 quad_perm:[2,3,0,1] row_mask:0xf bank_mask:0xf
    v_add_f32_dpp v98, v98, v98 quad_perm:[2,3,0,1] row_mask:0xf bank_mask:0xf
    v_add_f32_dpp v99, v99, v99 quad_perm:[2,3,0,1] row_mask:0xf bank_mask:0xf
    v_add_f32_dpp v96, v96, v96 row_half_mirror row_mask:0xf bank_mask:0xf
    v_add_f32_dpp v97, v97, v97 row_half_mirror row_mask:0xf bank_mask:0xf
    v_add_f32_dpp v98, v98, v98 row_half_mirror row_mask:0xf bank_mask:0xf
    v_add_f32_dpp v99, v99, v99 row_half_mirror row_mask:0xf bank_mask:0xf
    s_mov_b32 exec_lo, 0x01010101
    s_mov_b32 exec_hi, 0x01010101
    v_and_or_b32 v96, v96, s79, v8
    v_and_or_b32 v97, v97, s79, v9
    v_and_or_b32 v98, v98, s79, v10
    v_and_or_b32 v99, v99, s79, v11
    buffer_store_dwordx4 v[96:99], v28, s[40:43], s14 offen
    buffer_store_dwordx4 v[96:99], v28, s[40:43], s15 offen sc1
L_fin:
    s_endpgm
L_AC:
    s_waitcnt lgkmcnt(0)
    s_load_dword s77, s[40:41], 1044480
    v_mov_b32 v12, 0
    v_mov_b32 v13, 0
    v_mov_b32 v14, 0
    v_mov_b32 v15, 0
    v_lshlrev_b32 v16, 4, v1
    ds_write_b128 v16, v[12:15]
    s_lshr_b32 s13, s5, 3
    s_lshl_b32 s6, s4, 1
    s_add_u32 s13, s13, s6
    s_lshl_b32 s8, s13, 12
    s_add_u32 s8, s8, 393216
    s_lshl_b32 s6, s4, 4
    s_add_u32 s6, s6, s5
    s_lshl_b32 s10, s6, 4
    s_add_u32 s10, s10, 32768
    s_xor_b32 s11, s10, 524288
    s_lshl_b32 s14, s6, 10
    s_add_u32 s14, s14, 65536
    s_xor_b32 s15, s14, 524288
    v_lshrrev_b32 v17, 5, v1
    v_lshl_add_u32 v17, v17, 9, v16
    v_lshlrev_b32 v18, 2, v1
    v_and_b32 v20, 1, v1
    v_and_b32 v19, 14, v1
    v_lshlrev_b32 v19, 2, v19
    v_lshl_add_u32 v19, v20, 6, v19
    v_lshlrev_b32 v25, 9, v20
    v_lshl_add_u32 v25, v3, 7, v25
    v_lshrrev_b32 v20, 1, v2
    v_lshl_add_u32 v25, v20, 4, v25
    v_mov_b32 v20, 0
    s_mul_i32 s12, s4, 9
    s_add_u32 s12, s12, s5
    s_mul_i32 s16, s12, 2304
    s_add_u32 s16, s16, 1048576
    s_lshr_b32 s6, s12, 1
    s_lshl_b32 s6, s6, 4
    s_and_b32 s7, s12, 1
    s_lshl_b32 s7, s7, 2
    s_add_u32 s6, s6, s7
    s_lshr_b32 s17, s12, 2
    s_lshl_b32 s17, s17, 7
    s_lshl_b32 s7, s7, 4
    s_add_u32 s17, s17, s7
    s_add_u32 s17, s17, 327680
    s_bitcmp1_b32 s12, 1
    s_cselect_b64 s[20:21], -1, 0
    s_lshl_b32 s6, s6, 1
    v_lshrrev_b32 v21, 1, v2
    v_mul_u32_u24 v21, 2304, v21
    v_lshrrev_b32 v22, 1, v3
    v_lshl_add_u32 v22, v22, 4, s6
    v_and_b32 v23, 1, v3
    v_lshl_add_u32 v22, v23, 1, v22
    v_lshl_add_u32 v21, v23, 4, v21
    v_and_b32 v23, 1, v1
    v_lshl_add_u32 v22, v23, 2, v22
    v_lshl_add_u32 v21, v23, 5, v21
    v_mov_b32 v23, 0
    buffer_load_short_d16_hi v23, v22, s[60:63], 0 offen
    v_mov_b32 v40, 0
    v_mov_b32 v41, 0
    v_mov_b32 v42, 0
    v_mov_b32 v43, 0
    v_mov_b32 v44, 0
    v_mov_b32 v45, 0
    v_mov_b32 v46, 0
    v_mov_b32 v47, 0
    v_mov_b32 v48, 0
    v_mov_b32 v49, 0
    v_mov_b32 v50, 0
    v_mov_b32 v51, 0
    s_waitcnt lgkmcnt(0)
    s_mul_i32 s76, s77, 1664525
    s_add_u32 s76, s76, 1013904223
    s_bfe_u32 s6, s76, 0x80000
    v_mov_b32 v8, s6
    s_bfe_u32 s6, s76, 0x80008
    v_mov_b32 v9, s6
    s_bfe_u32 s6, s76, 0x80010
    v_mov_b32 v10, s6
    s_bfe_u32 s6, s76, 0x80018
    v_mov_b32 v11, s6
    v_xor_b32 v28, 1, v8
    buffer_store_dwordx4 v[28:31], v16, s[40:43], s14 offen
    s_mov_b64 exec, 1
    buffer_store_dwordx4 v[28:31], v20, s[40:43], s10 offen
    s_mov_b64 exec, -1
    buffer_load_dwordx4 v[128:131], v17, s[40:43], s8 offen offset:0 sc1
    buffer_load_dwordx4 v[132:135], v17, s[40:43], s8 offen offset:512 sc1
    buffer_load_dwordx4 v[136:139], v17, s[40:43], s8 offen offset:2048 sc1
    buffer_load_dwordx4 v[140:143], v17, s[40:43], s8 offen offset:2560 sc1
    s_waitcnt vmcnt(3)
    v_bitop3_b32 v52, v129, v131, s76 bitop3:0x7e
    s_waitcnt vmcnt(2)
    v_bitop3_b32 v53, v133, v135, s76 bitop3:0x7e
    s_waitcnt vmcnt(1)
    v_bitop3_b32 v54, v137, v139, s76 bitop3:0x7e
    s_waitcnt vmcnt(0)
    v_bitop3_b32 v55, v141, v143, s76 bitop3:0x7e
    v_or3_b32 v56, v52, v53, v54
    v_or_b32 v56, v56, v55
    v_cmp_ne_u32 vcc, 0, v56
    s_cbranch_vccz L_pdone_2
    v_cmp_ne_u32 s[24:25], 0, v52
    v_cmp_ne_u32 s[26:27], 0, v53
    v_cmp_ne_u32 s[28:29], 0, v54
    v_cmp_ne_u32 s[30:31], 0, v55
    s_mov_b32 s80, 0
    s_nop 3
L_poll_1:
    s_mov_b64 exec, s[24:25]
    buffer_load_dwordx4 v[128:131], v17, s[40:43], s8 offen offset:0 sc1
    s_mov_b64 exec, s[26:27]
    buffer_load_dwordx4 v[132:135], v17, s[40:43], s8 offen offset:512 sc1
    s_mov_b64 exec, s[28:29]
    buffer_load_dwordx4 v[136:139], v17, s[40:43], s8 offen offset:2048 sc1
    s_mov_b64 exec, s[30:31]
    buffer_load_dwordx4 v[140:143], v17, s[40:43], s8 offen offset:2560 sc1
    s_mov_b64 exec, -1
    s_waitcnt vmcnt(3)
    v_bitop3_b32 v52, v129, v131, s76 bitop3:0x7e
    s_waitcnt vmcnt(2)
    v_bitop3_b32 v53, v133, v135, s76 bitop3:0x7e
    s_waitcnt vmcnt(1)
    v_bitop3_b32 v54, v137, v139, s76 bitop3:0x7e
    s_waitcnt vmcnt(0)
    v_bitop3_b32 v55, v141, v143, s76 bitop3:0x7e
    v_or3_b32 v56, v52, v53, v54
    v_or_b32 v56, v56, v55
    v_cmp_ne_u32 vcc, 0, v56
    s_cbranch_vccz L_pdone_2
    v_cmp_ne_u32 s[24:25], 0, v52
    v_cmp_ne_u32 s[26:27], 0, v53
    v_cmp_ne_u32 s[28:29], 0, v54
    v_cmp_ne_u32 s[30:31], 0, v55
    s_add_u32 s80, s80, 1
    s_cmp_ge_u32 s80, 64
    s_cselect_b32 s7, 524288, 0
    s_xor_b32 s8, s8, s7
    s_nop 1
    s_cmp_lt_u32 s80, 0x10000
    s_cbranch_scc1 L_poll_1
    s_endpgm
L_pdone_2:
    v_add_f32 v56, v128, v132
    v_add_f32 v57, v130, v134
    v_add_f32 v58, v136, v140
    v_add_f32 v59, v138, v142
    v_cvt_pk_bf16_f32 v56, v56, v57
    v_cvt_pk_bf16_f32 v57, v58, v59
    ds_write2st64_b32 v18, v56, v57 offset0:0 offset1:1
    s_waitcnt lgkmcnt(0)
    s_barrier
    s_barrier
    ds_read_b64 v[64:65], v19 offset:768
    s_waitcnt lgkmcnt(0)
    v_max_f32_dpp v32, v64, v64 quad_perm:[2,3,0,1] row_mask:0xf bank_mask:0xf
    s_nop 1
    v_max_f32_dpp v32, v32, v32 row_ror:4 row_mask:0xf bank_mask:0xf
    s_nop 1
    v_max_f32_dpp v32, v32, v32 row_ror:8 row_mask:0xf bank_mask:0xf
    v_sub_f32 v33, v64, v32
    v_mul_f32 v33, 0x3fb8aa3b, v33
    v_exp_f32 v33, v33
    s_nop 0
    v_mul_f32 v33, v33, v65
    s_nop 1
    v_add_f32_dpp v33, v33, v33 quad_perm:[2,3,0,1] row_mask:0xf bank_mask:0xf
    s_nop 1
    v_add_f32_dpp v33, v33, v33 row_ror:4 row_mask:0xf bank_mask:0xf
    s_nop 1
    v_add_f32_dpp v33, v33, v33 row_ror:8 row_mask:0xf bank_mask:0xf
    v_mov_b32_dpp v34, v32 quad_perm:[1,1,1,1] row_mask:0xf bank_mask:0xf
    s_nop 0
    v_mov_b32_dpp v35, v33 quad_perm:[1,1,1,1] row_mask:0xf bank_mask:0xf
    v_and_or_b32 v28, v32, s79, v8
    v_and_or_b32 v29, v33, s79, v9
    v_and_or_b32 v30, v34, s79, v10
    v_and_or_b32 v31, v35, s79, v11
    s_mov_b64 exec, 1
    buffer_store_dwordx4 v[28:31], v20, s[40:43], s10 offen
    buffer_store_dwordx4 v[28:31], v20, s[40:43], s11 offen sc1
    s_mov_b64 exec, -1
    s_barrier
    s_cmp_ge_u32 s5, 9
    s_cbranch_scc1 L_fin
    v_mov_b32 v26, 1044480
    s_sleep 8
    buffer_load_dwordx4 v[32:35], v21, s[40:43], s17 offen sc1
    s_waitcnt vmcnt(0)
    v_xor_b32 v52, v32, v8
    v_bitop3_b32 v52, v33, v9, v52 bitop3:0xbe
    v_bitop3_b32 v52, v34, v10, v52 bitop3:0xbe
    v_bitop3_b32 v52, v35, v11, v52 bitop3:0xbe
    v_and_b32 v53, 0xff, v52
    v_cmp_ne_u32 vcc, 0, v53
    s_cbranch_vccz L_pdone_4
    v_and_b32 v52, 0xff, v52
    v_cmp_ne_u32 s[24:25], 0, v52
    s_mov_b32 s80, 0
    s_nop 3
L_poll_3:
    s_mov_b64 exec, s[24:25]
    buffer_load_dwordx4 v[32:35], v21, s[40:43], s17 offen sc1
    s_mov_b64 exec, -1
    s_waitcnt vmcnt(0)
    v_xor_b32 v52, v32, v8
    v_bitop3_b32 v52, v33, v9, v52 bitop3:0xbe
    v_bitop3_b32 v52, v34, v10, v52 bitop3:0xbe
    v_bitop3_b32 v52, v35, v11, v52 bitop3:0xbe
    v_and_b32 v53, 0xff, v52
    v_cmp_ne_u32 vcc, 0, v53
    s_cbranch_vccz L_pdone_4
    v_and_b32 v52, 0xff, v52
    v_cmp_ne_u32 s[24:25], 0, v52
    s_add_u32 s80, s80, 1
    s_sleep 2
    s_nop 1
    s_cmp_lt_u32 s80, 0x10000
    s_cbranch_scc1 L_poll_3
    s_endpgm
L_pdone_4:
    s_mov_b32 s18, 0
    s_mov_b32 s19, -1
    v_cndmask_b32 v32, v32, v34, s[20:21]
    v_cndmask_b32 v33, v33, v35, s[20:21]
    v_cndmask_b32 v32, v32, v33, s[18:19]
    v_and_b32 v32, s79, v32
    s_nop 1
    v_add_f32_dpp v32, v32, v32 quad_perm:[2,3,0,1] row_mask:0xf bank_mask:0xf
    s_nop 1
    v_add_f32_dpp v32, v32, v32 row_ror:4 row_mask:0xf bank_mask:0xf
    s_nop 1
    v_add_f32_dpp v32, v32, v32 row_ror:8 row_mask:0xf bank_mask:0xf
    v_cvt_pk_bf16_f32 v32, v32, v32
    v_and_b32 v32, s78, v32
    v_add_f32 v32, v32, v23
    v_cvt_pk_bf16_f32 v32, v32, v32
    v_and_b32 v32, s78, v32
    v_mov_b32 v26, 1044480
    v_mov_b32 v27, s76
    s_mov_b32 exec_hi, 0xffff
    s_mov_b64 s[22:23], exec
    buffer_load_dwordx4 v[40:43], v16, s[40:43], s16 offen offset:0 sc1
    buffer_load_dwordx4 v[44:47], v16, s[40:43], s16 offen offset:768 sc1
    buffer_load_dwordx4 v[48:51], v16, s[40:43], s16 offen offset:1536 sc1
    s_waitcnt vmcnt(2)
    v_xor_b32 v52, v40, v8
    v_bitop3_b32 v52, v41, v9, v52 bitop3:0xbe
    v_bitop3_b32 v52, v42, v10, v52 bitop3:0xbe
    v_bitop3_b32 v52, v43, v11, v52 bitop3:0xbe
    s_waitcnt vmcnt(1)
    v_xor_b32 v53, v44, v8
    v_bitop3_b32 v53, v45, v9, v53 bitop3:0xbe
    v_bitop3_b32 v53, v46, v10, v53 bitop3:0xbe
    v_bitop3_b32 v53, v47, v11, v53 bitop3:0xbe
    s_waitcnt vmcnt(0)
    v_xor_b32 v54, v48, v8
    v_bitop3_b32 v54, v49, v9, v54 bitop3:0xbe
    v_bitop3_b32 v54, v50, v10, v54 bitop3:0xbe
    v_bitop3_b32 v54, v51, v11, v54 bitop3:0xbe
    v_or3_b32 v55, v52, v53, v54
    v_and_b32 v55, 0xff, v55
    v_cmp_ne_u32 vcc, 0, v55
    s_cbranch_vccz L_pdone_6
    v_and_b32 v52, 0xff, v52
    v_cmp_ne_u32 s[24:25], 0, v52
    v_and_b32 v53, 0xff, v53
    v_cmp_ne_u32 s[26:27], 0, v53
    v_and_b32 v54, 0xff, v54
    v_cmp_ne_u32 s[28:29], 0, v54
    s_mov_b32 s80, 0
    s_nop 3
L_poll_5:
    s_mov_b64 exec, s[24:25]
    buffer_load_dwordx4 v[40:43], v16, s[40:43], s16 offen offset:0 sc1
    s_mov_b64 exec, s[26:27]
    buffer_load_dwordx4 v[44:47], v16, s[40:43], s16 offen offset:768 sc1
    s_mov_b64 exec, s[28:29]
    buffer_load_dwordx4 v[48:51], v16, s[40:43], s16 offen offset:1536 sc1
    s_mov_b64 exec, s[22:23]
    s_waitcnt vmcnt(2)
    v_xor_b32 v52, v40, v8
    v_bitop3_b32 v52, v41, v9, v52 bitop3:0xbe
    v_bitop3_b32 v52, v42, v10, v52 bitop3:0xbe
    v_bitop3_b32 v52, v43, v11, v52 bitop3:0xbe
    s_waitcnt vmcnt(1)
    v_xor_b32 v53, v44, v8
    v_bitop3_b32 v53, v45, v9, v53 bitop3:0xbe
    v_bitop3_b32 v53, v46, v10, v53 bitop3:0xbe
    v_bitop3_b32 v53, v47, v11, v53 bitop3:0xbe
    s_waitcnt vmcnt(0)
    v_xor_b32 v54, v48, v8
    v_bitop3_b32 v54, v49, v9, v54 bitop3:0xbe
    v_bitop3_b32 v54, v50, v10, v54 bitop3:0xbe
    v_bitop3_b32 v54, v51, v11, v54 bitop3:0xbe
    v_or3_b32 v55, v52, v53, v54
    v_and_b32 v55, 0xff, v55
    v_cmp_ne_u32 vcc, 0, v55
    s_cbranch_vccz L_pdone_6
    v_and_b32 v52, 0xff, v52
    v_cmp_ne_u32 s[24:25], 0, v52
    v_and_b32 v53, 0xff, v53
    v_cmp_ne_u32 s[26:27], 0, v53
    v_and_b32 v54, 0xff, v54
    v_cmp_ne_u32 s[28:29], 0, v54
    s_add_u32 s80, s80, 1
    s_nop 1
    s_cmp_lt_u32 s80, 0x10000
    s_cbranch_scc1 L_poll_5
    s_endpgm
L_pdone_6:
    s_mov_b64 exec, -1
    v_and_b32 v40, s79, v40
    v_and_b32 v41, s79, v41
    v_and_b32 v42, s79, v42
    v_and_b32 v43, s79, v43
    v_and_b32 v44, s79, v44
    v_and_b32 v45, s79, v45
    v_and_b32 v46, s79, v46
    v_and_b32 v47, s79, v47
    v_and_b32 v48, s79, v48
    v_and_b32 v49, s79, v49
    v_and_b32 v50, s79, v50
    v_and_b32 v51, s79, v51
    v_pk_add_f32 v[56:57], v[40:41], v[44:45]
    v_pk_add_f32 v[58:59], v[42:43], v[46:47]
    v_pk_add_f32 v[56:57], v[56:57], v[48:49]
    v_pk_add_f32 v[58:59], v[58:59], v[50:51]
    s_nop 0
    v_permlane32_swap_b32 v56, v57
    v_permlane32_swap_b32 v58, v59
    v_add_f32 v56, v56, v57
    v_add_f32 v58, v58, v59
    s_nop 1
    v_permlane16_swap_b32 v56, v58
    v_add_f32 v56, v56, v58
    s_nop 1
    v_add_f32_dpp v56, v56, v56 quad_perm:[2,3,0,1] row_mask:0xf bank_mask:0xf
    s_nop 1
    v_add_f32_dpp v56, v56, v56 row_ror:4 row_mask:0xf bank_mask:0xf
    s_nop 1
    v_add_f32_dpp v56, v56, v56 row_ror:8 row_mask:0xf bank_mask:0xf
    v_cvt_pk_bf16_f32 v56, v56, v56
    v_and_b32 v56, s78, v56
    v_add_f32 v56, v56, v32
    v_cvt_pk_bf16_f32 v56, v56, v56
    s_mov_b32 exec_lo, 0x00030003
    s_mov_b32 exec_hi, 0x00030003
    buffer_store_short v56, v22, s[64:67], 0 offen
    s_cmp_lg_u32 s12, 0
    s_cbranch_scc1 L_Rend
    s_mov_b64 exec, 1
    buffer_store_dword v27, v26, s[40:43], 0 offen sc1
L_Rend:
    s_endpgm
L_nonA:
    v_bfe_u32 v140, v1, 1, 1
    v_lshrrev_b32 v141, 2, v2
    v_lshlrev_b32 v141, 5, v141
    v_and_b32 v18, 1, v1
    v_lshl_add_u32 v141, v18, 4, v141
    v_lshl_add_u32 v17, v3, 1, v140
    v_lshl_add_u32 v17, v17, 15, v141
    s_and_b32 s6, s5, 1
    s_mul_i32 s8, s6, 288
    s_lshl_b32 s6, s3, 5
    s_add_u32 s8, s8, s6
    s_lshl_b32 s9, s8, 13
    s_lshl_b32 s8, s8, 1
    s_lshl_b32 s6, s4, 10
    s_add_u32 s9, s9, s6
    s_lshr_b32 s6, s5, 1
    s_lshl_b32 s6, s6, 7
    s_add_u32 s9, s9, s6
    v_lshl_add_u32 v18, v3, 1, v18
    v_lshlrev_b32 v18, 3, v18
    v_lshlrev_b32 v16, 4, v1
    v_lshlrev_b32 v19, 2, v1
    s_waitcnt lgkmcnt(0)
    s_cmp_lg_u32 s3, 0
    s_cbranch_scc1 L_nx
    buffer_load_dwordx4 v[20:23], v16, s[60:63], 0 offen
    buffer_load_dword v24, v19, s[60:63], 0 offen offset:1024
L_nx:
    buffer_load_dwordx4 v[32:35], v17, s[68:71], s9 offen nt
    s_add_u32 s9, s9, 8192
    buffer_load_dwordx4 v[36:39], v17, s[68:71], s9 offen nt
    s_add_u32 s9, s9, 8192
    buffer_load_dwordx4 v[40:43], v17, s[68:71], s9 offen nt
    s_add_u32 s9, s9, 8192
    buffer_load_dwordx4 v[44:47], v17, s[68:71], s9 offen nt
    s_load_dword s77, s[40:41], 1044480
    v_mov_b32 v12, 0
    ds_write_b32 v19, v12 offset:6912
    v_bfe_u32 v12, v1, 1, 1
    v_lshlrev_b32 v12, 4, v12
    v_mov_b32 v13, 0xffff
    v_lshlrev_b32 v12, v12, v13
    v_lshrrev_b32 v13, 2, v2
    v_cmp_eq_u32 vcc, 0, v13
    s_nop 1
    v_cndmask_b32 v4, 0, v12, vcc
    v_cmp_eq_u32 vcc, 1, v13
    s_nop 1
    v_cndmask_b32 v5, 0, v12, vcc
    v_cmp_eq_u32 vcc, 2, v13
    s_nop 1
    v_cndmask_b32 v6, 0, v12, vcc
    v_cmp_eq_u32 vcc, 3, v13
    s_nop 1
    v_cndmask_b32 v7, 0, v12, vcc
    v_and_b32 v12, 1, v3
    v_lshrrev_b32 v15, 1, v3
    v_lshl_add_u32 v15, v12, 1, v15
    v_lshrrev_b32 v13, 1, v2
    v_add_lshl_u32 v17, v18, v13, 2
    s_lshl_b32 s6, s3, 8
    v_add_u32 v17, s6, v17
    s_lshl_b32 s6, s4, 4
    s_add_u32 s6, s6, s5
    s_lshl_b32 s10, s6, 9
    s_add_u32 s10, s10, 393216
    s_xor_b32 s11, s10, 524288
    v_add_u32 v25, s8, v18
    v_mov_b32 v12, 0
    v_mov_b32 v13, 0
    s_cmp_lg_u32 s3, 0
    s_cbranch_scc1 L_nx2
    s_waitcnt vmcnt(4)
    ds_write_b128 v16, v[20:23] offset:7168
    ds_write_b32 v19, v24 offset:8192
    v_dot2c_f32_bf16 v12, s81, v20
    v_dot2c_f32_bf16 v13, v20, v20
    v_dot2c_f32_bf16 v12, s81, v21
    v_dot2c_f32_bf16 v13, v21, v21
    v_dot2c_f32_bf16 v12, s81, v22
    v_dot2c_f32_bf16 v13, v22, v22
    v_dot2c_f32_bf16 v12, s81, v23
    v_dot2c_f32_bf16 v13, v23, v23
    v_dot2c_f32_bf16 v12, s81, v24
    v_dot2c_f32_bf16 v13, v24, v24
    s_nop 2
    v_permlane32_swap_b32 v12, v13
    v_add_f32 v12, v12, v13
    s_nop 1
    v_add_f32_dpp v12, v12, v12 quad_perm:[1,0,3,2] row_mask:0xf bank_mask:0xf
    s_nop 1
    v_add_f32_dpp v12, v12, v12 quad_perm:[2,3,0,1] row_mask:0xf bank_mask:0xf
    s_nop 1
    v_add_f32_dpp v12, v12, v12 row_half_mirror row_mask:0xf bank_mask:0xf
    s_nop 1
    v_add_f32_dpp v12, v12, v12 row_mirror row_mask:0xf bank_mask:0xf
    s_nop 1
    v_add_f32_dpp v12, v12, v12 row_bcast:15 row_mask:0xa bank_mask:0xf
    s_nop 0
    v_readlane_b32 s6, v12, 31
    v_readlane_b32 s7, v12, 63
    v_mov_b32 v14, 0x3ae38e39
    v_mul_f32 v12, s6, v14
    v_mul_f32 v13, s7, v14
    v_fma_f32 v13, -v12, v12, v13
    v_max_f32 v13, 0, v13
    v_cvt_pk_bf16_f32 v14, v12, v13
    v_and_b32 v13, s78, v14
    v_add_f32 v13, 0x3727c5ac, v13
    v_lshlrev_b32 v12, 16, v14
    v_cvt_pk_bf16_f32 v13, v13, v13
    v_and_b32 v13, s78, v13
    v_sqrt_f32 v13, v13
    s_nop 0
    v_cvt_pk_bf16_f32 v13, v13, v13
    v_and_b32 v13, s78, v13
    v_rcp_f32 v13, v13
    ds_write_b64 v16, v[12:13] offset:8448
    s_waitcnt lgkmcnt(0)
L_nx2:
    s_barrier
    ds_read_b64 v[26:27], v25 offset:7168
    ds_read_b64 v[12:13], v16 offset:8448
    s_waitcnt lgkmcnt(0)
    v_lshlrev_b32 v28, 16, v26
    v_and_b32 v29, s78, v26
    v_lshlrev_b32 v30, 16, v27
    v_and_b32 v31, s78, v27
    v_sub_f32 v28, v28, v12
    v_sub_f32 v29, v29, v12
    v_sub_f32 v30, v30, v12
    v_sub_f32 v31, v31, v12
    v_cvt_pk_bf16_f32 v28, v28, v28
    v_cvt_pk_bf16_f32 v29, v29, v29
    v_cvt_pk_bf16_f32 v30, v30, v30
    v_cvt_pk_bf16_f32 v31, v31, v31
    v_and_b32 v28, s78, v28
    v_and_b32 v29, s78, v29
    v_and_b32 v30, s78, v30
    v_and_b32 v31, s78, v31
    v_mul_f32 v28, v28, v13
    v_mul_f32 v29, v29, v13
    v_mul_f32 v30, v30, v13
    v_mul_f32 v31, v31, v13
    v_cvt_pk_bf16_f32 v28, v28, v28
    v_cvt_pk_bf16_f32 v29, v29, v29
    v_cvt_pk_bf16_f32 v30, v30, v30
    v_cvt_pk_bf16_f32 v31, v31, v31
    v_and_b32 v48, v4, v28
    v_and_b32 v49, v5, v28
    v_and_b32 v50, v6, v28
    v_and_b32 v51, v7, v28
    v_and_b32 v52, v4, v29
    v_and_b32 v53, v5, v29
    v_and_b32 v54, v6, v29
    v_and_b32 v55, v7, v29
    v_and_b32 v56, v4, v30
    v_and_b32 v57, v5, v30
    v_and_b32 v58, v6, v30
    v_and_b32 v59, v7, v30
    v_and_b32 v60, v4, v31
    v_and_b32 v61, v5, v31
    v_and_b32 v62, v6, v31
    v_and_b32 v63, v7, v31
    s_waitcnt vmcnt(3)
    v_mfma_f32_16x16x32_bf16 v[20:23], v[32:35], v[48:51], 0
    s_waitcnt vmcnt(2)
    v_mfma_f32_16x16x32_bf16 v[20:23], v[36:39], v[52:55], v[20:23]
    s_waitcnt vmcnt(1)
    v_mfma_f32_16x16x32_bf16 v[20:23], v[40:43], v[56:59], v[20:23]
    s_waitcnt vmcnt(0)
    v_mfma_f32_16x16x32_bf16 v[20:23], v[44:47], v[60:63], v[20:23]
    s_nop 7
    v_cndmask_b32 v20, v20, v23, s[82:83]
    v_cndmask_b32 v21, v21, v22, s[82:83]
    s_nop 1
    v_add_f32_dpp v20, v21, v20 quad_perm:[1,0,3,2] row_mask:0xf bank_mask:0xf
    ds_write_b32 v17, v20 offset:0
    s_waitcnt lgkmcnt(0)
    s_mul_i32 s76, s77, 1664525
    s_add_u32 s76, s76, 1013904223
    s_bfe_u32 s6, s76, 0x80000
    v_mov_b32 v8, s6
    s_bfe_u32 s6, s76, 0x80008
    v_mov_b32 v9, s6
    s_bfe_u32 s6, s76, 0x80010
    v_mov_b32 v10, s6
    s_bfe_u32 s6, s76, 0x80018
    v_mov_b32 v11, s6
    s_cmp_ge_u32 s5, 14
    s_cbranch_scc1 L_Qonly
    s_cmp_ge_u32 s5, 9
    s_cbranch_scc1 L_O
    s_mul_i32 s12, s4, 9
    s_add_u32 s12, s12, s5
    v_lshl_add_u32 v18, v15, 3, v140
    v_mul_u32_u24 v18, 9216, v18
    v_add_u32 v18, v18, v141
    s_mul_i32 s8, s3, 589824
    s_lshl_b32 s6, s12, 7
    s_add_u32 s8, s8, s6
    v_bfe_u32 v20, v1, 1, 1
    v_lshl_add_u32 v20, v3, 4, v20
    v_mul_u32_u24 v20, 1152, v20
    v_lshrrev_b32 v21, 2, v2
    v_lshl_add_u32 v20, v21, 5, v20
    v_and_b32 v22, 1, v1
    v_lshl_add_u32 v20, v22, 4, v20
    s_mul_i32 s9, s12, 73728
    s_lshl_b32 s6, s3, 7
    s_add_u32 s9, s9, s6
    v_and_b32 v22, 8, v1
    v_and_b32 v23, 7, v1
    v_lshl_add_u32 v22, v22, 2, v23
    v_lshl_add_u32 v22, v15, 3, v22
    v_lshlrev_b32 v22, 1, v22
    v_mov_b32 v23, 0
    buffer_load_short_d16_hi v23, v22, s[60:63], s6 offen
    buffer_load_dwordx4 v[64:67], v18, s[52:55], s8 offen nt
    s_add_u32 s8, s8, 18432
    buffer_load_dwordx4 v[68:71], v18, s[52:55], s8 offen nt
    s_add_u32 s8, s8, 18432
    s_barrier
    s_cmp_lg_u32 s3, 8
    s_cbranch_scc1 L_Q3F
    ds_read2st64_b32 v[32:33], v19 offset0:0 offset1:1
    ds_read2st64_b32 v[34:35], v19 offset0:2 offset1:3
    ds_read2st64_b32 v[36:37], v19 offset0:4 offset1:5
    ds_read2st64_b32 v[38:39], v19 offset0:6 offset1:7
    ds_read_b32 v40, v19 offset:2048
    s_waitcnt lgkmcnt(3)
    v_pk_add_f32 v[32:33], v[32:33], v[34:35]
    s_waitcnt lgkmcnt(1)
    v_pk_add_f32 v[36:37], v[36:37], v[38:39]
    v_pk_add_f32 v[32:33], v[32:33], v[36:37]
    s_waitcnt lgkmcnt(0)
    v_add_f32 v32, v32, v40
    v_add_f32 v32, v32, v33
    v_mov_b32 v33, s76
    v_lshlrev_b32 v44, 3, v1
    buffer_store_dwordx2 v[32:33], v44, s[40:43], s10 offen
    buffer_store_dwordx2 v[32:33], v44, s[40:43], s11 offen sc1
L_Q3F:
    s_barrier
    v_mul_u32_u24 v24, 2304, v3
    v_lshl_add_u32 v24, v2, 4, v24
    s_lshl_b32 s13, s3, 8
    s_add_u32 s13, s13, 327680
    s_add_u32 s14, s13, 9216
    v_lshrrev_b32 v25, 3, v2
    v_lshl_add_u32 v25, v3, 1, v25
    v_mul_u32_u24 v25, 2304, v25
    v_and_b32 v21, 1, v21
    v_lshl_add_u32 v25, v21, 4, v25
    s_mul_i32 s15, s3, 18432
    s_lshl_b32 s6, s12, 5
    s_add_u32 s15, s15, s6
    s_add_u32 s15, s15, 1048576
    v_lshrrev_b32 v26, 5, v1
    v_lshlrev_b32 v26, 2, v26
    v_mov_b32 v27, 0
    v_and_b32 v32, s81, v4
    v_and_b32 v33, s81, v5
    v_and_b32 v34, s81, v6
    v_and_b32 v35, s81, v7
    s_waitcnt vmcnt(1)
    s_nop 0
    v_mfma_f32_16x16x32_bf16 v[136:139], v[64:67], v[32:35], 0
    buffer_load_dwordx4 v[72:75], v18, s[52:55], s8 offen nt
    s_add_u32 s8, s8, 18432
    s_waitcnt vmcnt(1)
    v_mfma_f32_16x16x32_bf16 v[136:139], v[68:71], v[32:35], v[136:139]
    buffer_load_dwordx4 v[76:79], v18, s[52:55], s8 offen nt
    s_add_u32 s8, s8, 239616
    s_waitcnt vmcnt(1)
    v_mfma_f32_16x16x32_bf16 v[136:139], v[72:75], v[32:35], v[136:139]
    buffer_load_dwordx4 v[80:83], v18, s[52:55], s8 offen nt
    s_add_u32 s8, s8, 18432
    s_waitcnt vmcnt(1)
    v_mfma_f32_16x16x32_bf16 v[136:139], v[76:79], v[32:35], v[136:139]
    buffer_load_dwordx4 v[84:87], v18, s[52:55], s8 offen nt
    s_add_u32 s8, s8, 18432
    s_waitcnt vmcnt(1)
    v_mfma_f32_16x16x32_bf16 v[136:139], v[80:83], v[32:35], v[136:139]
    buffer_load_dwordx4 v[88:91], v18, s[52:55], s8 offen nt
    s_add_u32 s8, s8, 18432
    s_waitcnt vmcnt(1)
    v_mfma_f32_16x16x32_bf16 v[136:139], v[84:87], v[32:35], v[136:139]
    buffer_load_dwordx4 v[92:95], v18, s[52:55], s8 offen nt
    s_add_u32 s8, s8, 18432
    s_waitcnt vmcnt(1)
    v_mfma_f32_16x16x32_bf16 v[136:139], v[88:91], v[32:35], v[136:139]
    buffer_load_dwordx4 v[96:99], v20, s[56:59], s9 offen nt
    s_add_u32 s9, s9, 2304
    s_waitcnt vmcnt(1)
    v_mfma_f32_16x16x32_bf16 v[136:139], v[92:95], v[32:35], v[136:139]
    s_nop 7
    v_cndmask_b32 v136, v136, v139, s[82:83]
    v_cndmask_b32 v137, v137, v138, s[82:83]
    s_nop 1
    v_add_f32_dpp v136, v137, v136 quad_perm:[1,0,3,2] row_mask:0xf bank_mask:0xf
    ds_write_b32 v17, v136 offset:4608
    buffer_load_dwordx4 v[100:103], v20, s[56:59], s9 offen nt
    s_add_u32 s9, s9, 2304
    s_waitcnt vmcnt(1)
    buffer_load_dwordx4 v[104:107], v20, s[56:59], s9 offen nt
    s_add_u32 s9, s9, 2304
    buffer_load_dwordx4 v[108:111], v20, s[56:59], s9 offen nt
    s_add_u32 s9, s9, 2304
    s_waitcnt vmcnt(2)
    buffer_load_dwordx4 v[112:115], v20, s[56:59], s9 offen nt
    s_add_u32 s9, s9, 2304
    buffer_load_dwordx4 v[116:119], v20, s[56:59], s9 offen nt
    s_add_u32 s9, s9, 2304
    s_waitcnt vmcnt(3)
    buffer_load_dwordx4 v[120:123], v20, s[56:59], s9 offen nt
    s_add_u32 s9, s9, 2304
    buffer_load_dwordx4 v[124:127], v20, s[56:59], s9 offen nt
    s_add_u32 s9, s9, 2304
    s_waitcnt lgkmcnt(0)
    s_barrier
    ds_read2st64_b32 v[144:145], v19 offset0:18 offset1:19
    ds_read2st64_b32 v[146:147], v19 offset0:20 offset1:21
    ds_read2st64_b32 v[148:149], v19 offset0:22 offset1:23
    ds_read2st64_b32 v[150:151], v19 offset0:24 offset1:25
    ds_read_b32 v152, v19 offset:6656
    s_waitcnt lgkmcnt(3)
    v_pk_add_f32 v[144:145], v[144:145], v[146:147]
    s_waitcnt lgkmcnt(1)
    v_pk_add_f32 v[148:149], v[148:149], v[150:151]
    v_pk_add_f32 v[144:145], v[144:145], v[148:149]
    s_waitcnt lgkmcnt(0)
    v_add_f32 v144, v144, v152
    v_add_f32 v144, v144, v145
    buffer_load_dwordx4 v[128:131], v24, s[40:43], s13 offen sc1
    buffer_load_dwordx4 v[132:135], v24, s[40:43], s14 offen sc1
    s_waitcnt vmcnt(1)
    v_xor_b32 v28, v128, v8
    v_bitop3_b32 v28, v129, v9, v28 bitop3:0xbe
    v_bitop3_b32 v28, v130, v10, v28 bitop3:0xbe
    v_bitop3_b32 v28, v131, v11, v28 bitop3:0xbe
    s_waitcnt vmcnt(0)
    v_xor_b32 v29, v132, v8
    v_bitop3_b32 v29, v133, v9, v29 bitop3:0xbe
    v_bitop3_b32 v29, v134, v10, v29 bitop3:0xbe
    v_bitop3_b32 v29, v135, v11, v29 bitop3:0xbe
    v_bitop3_b32 v30, v28, v29, s79 bitop3:0x54
    v_cmp_ne_u32 vcc, 0, v30
    s_cbranch_vccz L_pdone_8
    v_and_b32 v28, 0xff, v28
    v_cmp_ne_u32 s[24:25], 0, v28
    v_and_b32 v29, 0xff, v29
    v_cmp_ne_u32 s[26:27], 0, v29
    s_mov_b32 s80, 0
    s_nop 3
L_poll_7:
    s_mov_b64 exec, s[24:25]
    buffer_load_dwordx4 v[128:131], v24, s[40:43], s13 offen sc1
    s_mov_b64 exec, s[26:27]
    buffer_load_dwordx4 v[132:135], v24, s[40:43], s14 offen sc1
    s_mov_b64 exec, -1
    s_waitcnt vmcnt(1)
    v_xor_b32 v28, v128, v8
    v_bitop3_b32 v28, v129, v9, v28 bitop3:0xbe
    v_bitop3_b32 v28, v130, v10, v28 bitop3:0xbe
    v_bitop3_b32 v28, v131, v11, v28 bitop3:0xbe
    s_waitcnt vmcnt(0)
    v_xor_b32 v29, v132, v8
    v_bitop3_b32 v29, v133, v9, v29 bitop3:0xbe
    v_bitop3_b32 v29, v134, v10, v29 bitop3:0xbe
    v_bitop3_b32 v29, v135, v11, v29 bitop3:0xbe
    v_bitop3_b32 v30, v28, v29, s79 bitop3:0x54
    v_cmp_ne_u32 vcc, 0, v30
    s_cbranch_vccz L_pdone_8
    v_and_b32 v28, 0xff, v28
    v_cmp_ne_u32 s[24:25], 0, v28
    v_and_b32 v29, 0xff, v29
    v_cmp_ne_u32 s[26:27], 0, v29
    s_add_u32 s80, s80, 1
    s_sleep 1
    s_nop 1
    s_cmp_lt_u32 s80, 0x10000
    s_cbranch_scc1 L_poll_7
    s_endpgm
L_pdone_8:
    v_and_b32 v128, s79, v128
    v_and_b32 v129, s79, v129
    v_and_b32 v130, s79, v130
    v_and_b32 v131, s79, v131
    v_and_b32 v132, s79, v132
    v_and_b32 v133, s79, v133
    v_and_b32 v134, s79, v134
    v_and_b32 v135, s79, v135
    v_pk_add_f32 v[140:141], v[128:129], v[132:133]
    v_pk_add_f32 v[142:143], v[130:131], v[134:135]
    s_nop 0
    v_permlane32_swap_b32 v140, v141
    v_permlane32_swap_b32 v142, v143
    v_add_f32 v140, v140, v141
    v_add_f32 v142, v142, v143
    s_nop 1
    v_permlane16_swap_b32 v140, v142
    v_add_f32 v140, v140, v142
    v_cvt_pk_bf16_f32 v140, v140, v140
    v_and_b32 v140, s78, v140
    v_add_f32 v140, v140, v23
    v_cvt_pk_bf16_f32 v140, v140, v140
    s_nop 1
    v_mov_b32_dpp v141, v140 row_ror:4 row_mask:0xf bank_mask:0xf
    v_mov_b32_dpp v142, v140 row_ror:8 row_mask:0xf bank_mask:0xf
    v_mov_b32_dpp v143, v140 row_ror:12 row_mask:0xf bank_mask:0xf
    v_and_b32_dpp v32, v140, v4 quad_perm:[0,1,0,1] row_mask:0xf bank_mask:0xf
    v_and_b32_dpp v33, v141, v5 quad_perm:[0,1,0,1] row_mask:0xf bank_mask:0xf
    v_and_b32_dpp v34, v142, v6 quad_perm:[0,1,0,1] row_mask:0xf bank_mask:0xf
    v_and_b32_dpp v35, v143, v7 quad_perm:[0,1,0,1] row_mask:0xf bank_mask:0xf
    v_and_b32_dpp v36, v140, v4 quad_perm:[2,3,2,3] row_mask:0xf bank_mask:0xf
    v_and_b32_dpp v37, v141, v5 quad_perm:[2,3,2,3] row_mask:0xf bank_mask:0xf
    v_and_b32_dpp v38, v142, v6 quad_perm:[2,3,2,3] row_mask:0xf bank_mask:0xf
    v_and_b32_dpp v39, v143, v7 quad_perm:[2,3,2,3] row_mask:0xf bank_mask:0xf
    v_mfma_f32_16x16x32_bf16 v[136:139], v[64:67], v[32:35], 0
    v_and_b32_dpp v40, v143, v4 quad_perm:[0,1,0,1] row_mask:0xf bank_mask:0xf
    v_and_b32_dpp v41, v140, v5 quad_perm:[0,1,0,1] row_mask:0xf bank_mask:0xf
    v_and_b32_dpp v42, v141, v6 quad_perm:[0,1,0,1] row_mask:0xf bank_mask:0xf
    v_and_b32_dpp v43, v142, v7 quad_perm:[0,1,0,1] row_mask:0xf bank_mask:0xf
    v_mfma_f32_16x16x32_bf16 v[136:139], v[68:71], v[36:39], v[136:139]
    v_and_b32_dpp v44, v143, v4 quad_perm:[2,3,2,3] row_mask:0xf bank_mask:0xf
    v_and_b32_dpp v45, v140, v5 quad_perm:[2,3,2,3] row_mask:0xf bank_mask:0xf
    v_and_b32_dpp v46, v141, v6 quad_perm:[2,3,2,3] row_mask:0xf bank_mask:0xf
    v_and_b32_dpp v47, v142, v7 quad_perm:[2,3,2,3] row_mask:0xf bank_mask:0xf
    v_mfma_f32_16x16x32_bf16 v[136:139], v[72:75], v[40:43], v[136:139]
    v_and_b32_dpp v48, v142, v4 quad_perm:[0,1,0,1] row_mask:0xf bank_mask:0xf
    v_and_b32_dpp v49, v143, v5 quad_perm:[0,1,0,1] row_mask:0xf bank_mask:0xf
    v_and_b32_dpp v50, v140, v6 quad_perm:[0,1,0,1] row_mask:0xf bank_mask:0xf
    v_and_b32_dpp v51, v141, v7 quad_perm:[0,1,0,1] row_mask:0xf bank_mask:0xf
    v_mfma_f32_16x16x32_bf16 v[136:139], v[76:79], v[44:47], v[136:139]
    v_and_b32_dpp v52, v142, v4 quad_perm:[2,3,2,3] row_mask:0xf bank_mask:0xf
    v_and_b32_dpp v53, v143, v5 quad_perm:[2,3,2,3] row_mask:0xf bank_mask:0xf
    v_and_b32_dpp v54, v140, v6 quad_perm:[2,3,2,3] row_mask:0xf bank_mask:0xf
    v_and_b32_dpp v55, v141, v7 quad_perm:[2,3,2,3] row_mask:0xf bank_mask:0xf
    v_mfma_f32_16x16x32_bf16 v[136:139], v[80:83], v[48:51], v[136:139]
    v_and_b32_dpp v56, v141, v4 quad_perm:[0,1,0,1] row_mask:0xf bank_mask:0xf
    v_and_b32_dpp v57, v142, v5 quad_perm:[0,1,0,1] row_mask:0xf bank_mask:0xf
    v_and_b32_dpp v58, v143, v6 quad_perm:[0,1,0,1] row_mask:0xf bank_mask:0xf
    v_and_b32_dpp v59, v140, v7 quad_perm:[0,1,0,1] row_mask:0xf bank_mask:0xf
    v_mfma_f32_16x16x32_bf16 v[136:139], v[84:87], v[52:55], v[136:139]
    v_and_b32_dpp v60, v141, v4 quad_perm:[2,3,2,3] row_mask:0xf bank_mask:0xf
    v_and_b32_dpp v61, v142, v5 quad_perm:[2,3,2,3] row_mask:0xf bank_mask:0xf
    v_and_b32_dpp v62, v143, v6 quad_perm:[2,3,2,3] row_mask:0xf bank_mask:0xf
    v_and_b32_dpp v63, v140, v7 quad_perm:[2,3,2,3] row_mask:0xf bank_mask:0xf
    v_mfma_f32_16x16x32_bf16 v[136:139], v[88:91], v[56:59], v[136:139]
    s_nop 0
    v_mfma_f32_16x16x32_bf16 v[136:139], v[92:95], v[60:63], v[136:139]
    v_and_b32 v28, s78, v140
    v_mul_f32 v29, v28, v28
    s_nop 1
    v_permlane32_swap_b32 v28, v29
    v_add_f32 v28, v28, v29
    s_nop 1
    v_add_f32_dpp v28, v28, v28 quad_perm:[1,0,3,2] row_mask:0xf bank_mask:0xf
    s_nop 1
    v_add_f32_dpp v28, v28, v28 quad_perm:[2,3,0,1] row_mask:0xf bank_mask:0xf
    s_nop 1
    v_add_f32_dpp v28, v28, v28 row_half_mirror row_mask:0xf bank_mask:0xf
    s_nop 1
    v_add_f32_dpp v28, v28, v28 row_mirror row_mask:0xf bank_mask:0xf
    s_nop 1
    v_add_f32_dpp v28, v28, v28 row_bcast:15 row_mask:0xa bank_mask:0xf
    s_mov_b32 exec_lo, 0x80000000
    s_mov_b32 exec_hi, 0x80000000
    ds_add_f32 v26, v28 offset:6912
    s_mov_b64 exec, -1
    v_cndmask_b32 v136, v136, v139, s[82:83]
    v_cndmask_b32 v137, v137, v138, s[82:83]
    s_nop 1
    v_add_f32_dpp v136, v137, v136 quad_perm:[1,0,3,2] row_mask:0xf bank_mask:0xf
    ds_write_b32 v17, v136 offset:2304
    s_waitcnt lgkmcnt(0)
    s_barrier
    ds_read_b64 v[28:29], v27 offset:6912
    ds_read2st64_b32 v[154:155], v19 offset0:9 offset1:10
    ds_read2st64_b32 v[156:157], v19 offset0:11 offset1:12
    ds_read2st64_b32 v[158:159], v19 offset0:13 offset1:14
    ds_read2st64_b32 v[160:161], v19 offset0:15 offset1:16
    ds_read_b32 v162, v19 offset:4352
    s_waitcnt lgkmcnt(5)
    v_mul_f32 v28, 0x3ae38e39, v28
    v_mul_f32 v29, 0x3ae38e39, v29
    v_fma_f32 v29, -v28, v28, v29
    v_max_f32 v29, 0, v29
    v_cvt_pk_bf16_f32 v27, v28, v29
    v_and_b32 v29, s78, v27
    v_add_f32 v29, 0x3727c5ac, v29
    v_lshlrev_b32 v28, 16, v27
    v_cvt_pk_bf16_f32 v29, v29, v29
    v_and_b32 v29, s78, v29
    v_sqrt_f32 v29, v29
    s_nop 0
    v_cvt_pk_bf16_f32 v29, v29, v29
    v_and_b32 v29, s78, v29
    v_rcp_f32 v29, v29
    s_waitcnt lgkmcnt(3)
    v_pk_add_f32 v[154:155], v[154:155], v[156:157]
    s_waitcnt lgkmcnt(1)
    v_pk_add_f32 v[158:159], v[158:159], v[160:161]
    v_pk_add_f32 v[154:155], v[154:155], v[158:159]
    s_waitcnt lgkmcnt(0)
    v_add_f32 v154, v154, v162
    v_add_f32 v154, v154, v155
    v_fma_f32 v30, -v28, v144, v154
    v_mul_f32 v30, v30, v29
    v_cvt_pk_bf16_f32 v30, v30, v30
    v_and_b32 v30, s78, v30
    v_mul_f32 v31, 0xbfb8aa3b, v30
    v_exp_f32 v31, v31
    s_nop 0
    v_add_f32 v31, 1.0, v31
    v_rcp_f32 v31, v31
    s_nop 0
    v_mul_f32 v30, v30, v31
    v_cvt_pk_bf16_f32 v140, v30, v30
    s_nop 1
    v_mov_b32_dpp v141, v140 row_ror:4 row_mask:0xf bank_mask:0xf
    v_mov_b32_dpp v142, v140 row_ror:8 row_mask:0xf bank_mask:0xf
    v_mov_b32_dpp v143, v140 row_ror:12 row_mask:0xf bank_mask:0xf
    v_and_b32_dpp v32, v140, v4 quad_perm:[0,1,0,1] row_mask:0xf bank_mask:0xf
    v_and_b32_dpp v33, v141, v5 quad_perm:[0,1,0,1] row_mask:0xf bank_mask:0xf
    v_and_b32_dpp v34, v142, v6 quad_perm:[0,1,0,1] row_mask:0xf bank_mask:0xf
    v_and_b32_dpp v35, v143, v7 quad_perm:[0,1,0,1] row_mask:0xf bank_mask:0xf
    v_and_b32_dpp v36, v140, v4 quad_perm:[2,3,2,3] row_mask:0xf bank_mask:0xf
    v_and_b32_dpp v37, v141, v5 quad_perm:[2,3,2,3] row_mask:0xf bank_mask:0xf
    v_and_b32_dpp v38, v142, v6 quad_perm:[2,3,2,3] row_mask:0xf bank_mask:0xf
    v_and_b32_dpp v39, v143, v7 quad_perm:[2,3,2,3] row_mask:0xf bank_mask:0xf
    v_mfma_f32_16x16x32_bf16 v[136:139], v[96:99], v[32:35], 0
    v_and_b32_dpp v40, v143, v4 quad_perm:[0,1,0,1] row_mask:0xf bank_mask:0xf
    v_and_b32_dpp v41, v140, v5 quad_perm:[0,1,0,1] row_mask:0xf bank_mask:0xf
    v_and_b32_dpp v42, v141, v6 quad_perm:[0,1,0,1] row_mask:0xf bank_mask:0xf
    v_and_b32_dpp v43, v142, v7 quad_perm:[0,1,0,1] row_mask:0xf bank_mask:0xf
    v_mfma_f32_16x16x32_bf16 v[136:139], v[100:103], v[36:39], v[136:139]
    v_and_b32_dpp v44, v143, v4 quad_perm:[2,3,2,3] row_mask:0xf bank_mask:0xf
    v_and_b32_dpp v45, v140, v5 quad_perm:[2,3,2,3] row_mask:0xf bank_mask:0xf
    v_and_b32_dpp v46, v141, v6 quad_perm:[2,3,2,3] row_mask:0xf bank_mask:0xf
    v_and_b32_dpp v47, v142, v7 quad_perm:[2,3,2,3] row_mask:0xf bank_mask:0xf
    v_mfma_f32_16x16x32_bf16 v[136:139], v[104:107], v[40:43], v[136:139]
    v_and_b32_dpp v48, v142, v4 quad_perm:[0,1,0,1] row_mask:0xf bank_mask:0xf
    v_and_b32_dpp v49, v143, v5 quad_perm:[0,1,0,1] row_mask:0xf bank_mask:0xf
    v_and_b32_dpp v50, v140, v6 quad_perm:[0,1,0,1] row_mask:0xf bank_mask:0xf
    v_and_b32_dpp v51, v141, v7 quad_perm:[0,1,0,1] row_mask:0xf bank_mask:0xf
    v_mfma_f32_16x16x32_bf16 v[136:139], v[108:111], v[44:47], v[136:139]
    v_and_b32_dpp v52, v142, v4 quad_perm:[2,3,2,3] row_mask:0xf bank_mask:0xf
    v_and_b32_dpp v53, v143, v5 quad_perm:[2,3,2,3] row_mask:0xf bank_mask:0xf
    v_and_b32_dpp v54, v140, v6 quad_perm:[2,3,2,3] row_mask:0xf bank_mask:0xf
    v_and_b32_dpp v55, v141, v7 quad_perm:[2,3,2,3] row_mask:0xf bank_mask:0xf
    v_mfma_f32_16x16x32_bf16 v[136:139], v[112:115], v[48:51], v[136:139]
    v_and_b32_dpp v56, v141, v4 quad_perm:[0,1,0,1] row_mask:0xf bank_mask:0xf
    v_and_b32_dpp v57, v142, v5 quad_perm:[0,1,0,1] row_mask:0xf bank_mask:0xf
    v_and_b32_dpp v58, v143, v6 quad_perm:[0,1,0,1] row_mask:0xf bank_mask:0xf
    v_and_b32_dpp v59, v140, v7 quad_perm:[0,1,0,1] row_mask:0xf bank_mask:0xf
    v_mfma_f32_16x16x32_bf16 v[136:139], v[116:119], v[52:55], v[136:139]
    v_and_b32_dpp v60, v141, v4 quad_perm:[2,3,2,3] row_mask:0xf bank_mask:0xf
    v_and_b32_dpp v61, v142, v5 quad_perm:[2,3,2,3] row_mask:0xf bank_mask:0xf
    v_and_b32_dpp v62, v143, v6 quad_perm:[2,3,2,3] row_mask:0xf bank_mask:0xf
    v_and_b32_dpp v63, v140, v7 quad_perm:[2,3,2,3] row_mask:0xf bank_mask:0xf
    v_mfma_f32_16x16x32_bf16 v[136:139], v[120:123], v[56:59], v[136:139]
    s_nop 0
    v_mfma_f32_16x16x32_bf16 v[136:139], v[124:127], v[60:63], v[136:139]
    s_nop 7
    v_add_f32_dpp v136, v138, v136 quad_perm:[1,0,3,2] row_mask:0xf bank_mask:0xf
    v_add_f32_dpp v137, v139, v137 quad_perm:[1,0,3,2] row_mask:0xf bank_mask:0xf
    s_nop 0
    v_mov_b32_dpp v138, v136 quad_perm:[2,2,2,2] row_mask:0xf bank_mask:0xf
    v_mov_b32_dpp v139, v137 quad_perm:[2,2,2,2] row_mask:0xf bank_mask:0xf
    s_mov_b32 exec_lo, 0x11111111
    s_mov_b32 exec_hi, 0x11111111
    v_and_or_b32 v136, v136, s79, v8
    v_and_or_b32 v137, v137, s79, v9
    v_and_or_b32 v138, v138, s79, v10
    v_and_or_b32 v139, v139, s79, v11
    buffer_store_dwordx4 v[136:139], v25, s[40:43], s15 offen sc1
    s_endpgm
L_O:
    s_sub_u32 s12, s5, 9
    s_cmp_eq_u32 s12, 4
    s_cselect_b32 s18, 0x00ff00ff, -1
    s_mov_b32 s19, s18
    s_cselect_b32 s20, 2, 4
    s_mul_i32 s15, s4, 2304
    s_lshl_b32 s6, s12, 9
    s_add_u32 s15, s15, s6
    s_add_u32 s15, s15, 327680
    s_cmp_eq_u32 s3, 8
    s_cbranch_scc1 L_Opub
    v_mul_u32_u24 v18, 9216, v15
    v_lshl_add_u32 v18, v2, 4, v18
    s_lshl_b32 s6, s4, 3
    s_add_u32 s6, s6, s3
    s_mul_i32 s8, s6, 73728
    s_lshl_b32 s7, s12, 8
    s_add_u32 s8, s8, s7
    s_mov_b64 exec, s[18:19]
    buffer_load_dwordx4 v[64:67], v18, s[72:75], s8 offen nt
    s_add_u32 s8, s8, 1152
    buffer_load_dwordx4 v[68:71], v18, s[72:75], s8 offen nt
    s_add_u32 s8, s8, 1152
    buffer_load_dwordx4 v[72:75], v18, s[72:75], s8 offen nt
    s_add_u32 s8, s8, 1152
    buffer_load_dwordx4 v[76:79], v18, s[72:75], s8 offen nt
    s_add_u32 s8, s8, 1152
    buffer_load_dwordx4 v[80:83], v18, s[72:75], s8 offen nt
    s_add_u32 s8, s8, 1152
    buffer_load_dwordx4 v[84:87], v18, s[72:75], s8 offen nt
    s_add_u32 s8, s8, 1152
    buffer_load_dwordx4 v[88:91], v18, s[72:75], s8 offen nt
    s_add_u32 s8, s8, 1152
    buffer_load_dwordx4 v[92:95], v18, s[72:75], s8 offen nt
    s_add_u32 s8, s8, 28800
    s_barrier
    s_barrier
    buffer_load_dwordx4 v[96:99], v18, s[72:75], s8 offen nt
    s_add_u32 s8, s8, 1152
    buffer_load_dwordx4 v[100:103], v18, s[72:75], s8 offen nt
    s_add_u32 s8, s8, 1152
    buffer_load_dwordx4 v[104:107], v18, s[72:75], s8 offen nt
    s_add_u32 s8, s8, 1152
    buffer_load_dwordx4 v[108:111], v18, s[72:75], s8 offen nt
    s_add_u32 s8, s8, 1152
    buffer_load_dwordx4 v[112:115], v18, s[72:75], s8 offen nt
    s_add_u32 s8, s8, 1152
    buffer_load_dwordx4 v[116:119], v18, s[72:75], s8 offen nt
    s_add_u32 s8, s8, 1152
    buffer_load_dwordx4 v[120:123], v18, s[72:75], s8 offen nt
    s_add_u32 s8, s8, 1152
    buffer_load_dwordx4 v[124:127], v18, s[72:75], s8 offen nt
    s_add_u32 s8, s8, 1152
    s_mov_b64 exec, -1
    s_lshr_b32 s6, s6, 2
    s_lshl_b32 s9, s6, 7
    s_add_u32 s9, s9, 32768
    s_lshl_b32 s13, s6, 13
    s_and_b32 s7, s3, 3
    s_lshl_b32 s7, s7, 8
    s_add_u32 s13, s13, s7
    s_add_u32 s13, s13, 65536
    s_add_u32 s14, s13, 4096
    s_bitcmp1_b32 s3, 1
    s_cselect_b64 s[22:23], -1, 0
    v_add_u32 v20, v2, v3
    v_and_b32 v20, 7, v20
    v_lshlrev_b32 v20, 4, v20
    v_lshlrev_b32 v21, 10, v3
    v_lshl_add_u32 v21, v2, 4, v21
    s_mul_i32 s7, s3, 528
    v_lshl_add_u32 v22, v1, 3, s7
    v_and_b32 v23, 7, v1
    v_mul_u32_u24 v23, 528, v23
    s_lshl_b32 s7, s3, 7
    v_lshrrev_b32 v17, 3, v1
    v_lshl_add_u32 v17, v17, 4, s7
    v_add_u32 v23, v23, v17
    s_mov_b64 exec, s[18:19]
    s_mov_b64 exec, -1
    buffer_load_dwordx4 v[24:27], v20, s[40:43], s9 offen sc1
    buffer_load_dwordx4 v[160:163], v21, s[40:43], s13 offen sc1
    buffer_load_dwordx4 v[164:167], v21, s[40:43], s14 offen sc1
    s_waitcnt vmcnt(2)
    v_xor_b32 v28, v24, v8
    v_bitop3_b32 v28, v25, v9, v28 bitop3:0xbe
    v_bitop3_b32 v28, v26, v10, v28 bitop3:0xbe
    v_bitop3_b32 v28, v27, v11, v28 bitop3:0xbe
    s_waitcnt vmcnt(1)
    v_xor_b32 v29, v160, v8
    v_bitop3_b32 v29, v161, v9, v29 bitop3:0xbe
    v_bitop3_b32 v29, v162, v10, v29 bitop3:0xbe
    v_bitop3_b32 v29, v163, v11, v29 bitop3:0xbe
    s_waitcnt vmcnt(0)
    v_xor_b32 v30, v164, v8
    v_bitop3_b32 v30, v165, v9, v30 bitop3:0xbe
    v_bitop3_b32 v30, v166, v10, v30 bitop3:0xbe
    v_bitop3_b32 v30, v167, v11, v30 bitop3:0xbe
    v_or3_b32 v31, v28, v29, v30
    v_and_b32 v31, 0xff, v31
    v_cmp_ne_u32 vcc, 0, v31
    s_cbranch_vccz L_pdone_10
    v_and_b32 v28, 0xff, v28
    v_cmp_ne_u32 s[24:25], 0, v28
    v_and_b32 v29, 0xff, v29
    v_cmp_ne_u32 s[26:27], 0, v29
    v_and_b32 v30, 0xff, v30
    v_cmp_ne_u32 s[28:29], 0, v30
    s_mov_b32 s80, 0
    s_nop 3
L_poll_9:
    s_mov_b64 exec, s[24:25]
    buffer_load_dwordx4 v[24:27], v20, s[40:43], s9 offen sc1
    s_mov_b64 exec, s[26:27]
    buffer_load_dwordx4 v[160:163], v21, s[40:43], s13 offen sc1
    s_mov_b64 exec, s[28:29]
    buffer_load_dwordx4 v[164:167], v21, s[40:43], s14 offen sc1
    s_mov_b64 exec, -1
    s_waitcnt vmcnt(2)
    v_xor_b32 v28, v24, v8
    v_bitop3_b32 v28, v25, v9, v28 bitop3:0xbe
    v_bitop3_b32 v28, v26, v10, v28 bitop3:0xbe
    v_bitop3_b32 v28, v27, v11, v28 bitop3:0xbe
    s_waitcnt vmcnt(1)
    v_xor_b32 v29, v160, v8
    v_bitop3_b32 v29, v161, v9, v29 bitop3:0xbe
    v_bitop3_b32 v29, v162, v10, v29 bitop3:0xbe
    v_bitop3_b32 v29, v163, v11, v29 bitop3:0xbe
    s_waitcnt vmcnt(0)
    v_xor_b32 v30, v164, v8
    v_bitop3_b32 v30, v165, v9, v30 bitop3:0xbe
    v_bitop3_b32 v30, v166, v10, v30 bitop3:0xbe
    v_bitop3_b32 v30, v167, v11, v30 bitop3:0xbe
    v_or3_b32 v31, v28, v29, v30
    v_and_b32 v31, 0xff, v31
    v_cmp_ne_u32 vcc, 0, v31
    s_cbranch_vccz L_pdone_10
    v_and_b32 v28, 0xff, v28
    v_cmp_ne_u32 s[24:25], 0, v28
    v_and_b32 v29, 0xff, v29
    v_cmp_ne_u32 s[26:27], 0, v29
    v_and_b32 v30, 0xff, v30
    v_cmp_ne_u32 s[28:29], 0, v30
    s_add_u32 s80, s80, 1
    s_cmp_ge_u32 s80, 64
    s_cselect_b32 s7, 524288, 0
    s_xor_b32 s9, s9, s7
    s_xor_b32 s13, s13, s7
    s_xor_b32 s14, s14, s7
    s_nop 1
    s_cmp_lt_u32 s80, 0x10000
    s_cbranch_scc1 L_poll_9
    s_endpgm
L_pdone_10:
    v_cndmask_b32 v24, v24, v26, s[22:23]
    v_cndmask_b32 v25, v25, v27, s[22:23]
    v_and_b32 v24, s78, v24
    v_mov_b32 v26, v24
    v_and_b32 v25, s79, v25
    v_and_b32 v166, s79, v166
    v_and_b32 v167, s79, v167
    v_max_f32_dpp v26, v26, v26 quad_perm:[1,0,3,2] row_mask:0xf bank_mask:0xf
    v_and_b32 v160, s79, v160
    v_and_b32 v161, s79, v161
    v_max_f32_dpp v26, v26, v26 quad_perm:[2,3,0,1] row_mask:0xf bank_mask:0xf
    v_and_b32 v162, s79, v162
    v_and_b32 v163, s79, v163
    v_max_f32_dpp v26, v26, v26 row_half_mirror row_mask:0xf bank_mask:0xf
    v_and_b32 v164, s79, v164
    v_and_b32 v165, s79, v165
    v_sub_f32 v24, v24, v26
    v_mul_f32 v24, 0x3fb8aa3b, v24
    v_exp_f32 v24, v24
    s_nop 0
    v_mul_f32 v25, v24, v25
    s_nop 1
    v_add_f32_dpp v25, v25, v25 quad_perm:[1,0,3,2] row_mask:0xf bank_mask:0xf
    s_nop 1
    v_add_f32_dpp v25, v25, v25 quad_perm:[2,3,0,1] row_mask:0xf bank_mask:0xf
    s_nop 1
    v_add_f32_dpp v25, v25, v25 row_half_mirror row_mask:0xf bank_mask:0xf
    v_rcp_f32 v25, v25
    s_nop 0
    v_mul_f32 v24, v24, v25
    s_nop 1
    v_mov_b32_dpp v26, v24 row_newbcast:0 row_mask:0xf bank_mask:0xf
    v_mov_b32_dpp v27, v24 row_newbcast:4 row_mask:0xf bank_mask:0xf
    v_pk_mul_f32 v[12:13], v[160:161], v[26:27] op_sel:[0,0] op_sel_hi:[1,0]
    v_pk_mul_f32 v[14:15], v[162:163], v[26:27] op_sel:[0,0] op_sel_hi:[1,0]
    v_pk_fma_f32 v[12:13], v[164:165], v[26:27], v[12:13] op_sel:[0,1,0] op_sel_hi:[1,1,1]
    v_pk_fma_f32 v[14:15], v[166:167], v[26:27], v[14:15] op_sel:[0,1,0] op_sel_hi:[1,1,1]
    s_nop 0
    v_permlane32_swap_b32 v12, v13
    v_permlane32_swap_b32 v14, v15
    v_add_f32 v12, v12, v13
    v_add_f32 v14, v14, v15
    s_nop 1
    v_permlane16_swap_b32 v12, v14
    v_add_f32 v12, v12, v14
    v_cvt_pk_bf16_f32 v12, v12, v12
    s_nop 1
    v_and_b32_dpp v32, v12, v4 row_newbcast:0 row_mask:0xf bank_mask:0xf
    v_and_b32_dpp v33, v12, v5 row_newbcast:0 row_mask:0xf bank_mask:0xf
    v_and_b32_dpp v34, v12, v6 row_newbcast:0 row_mask:0xf bank_mask:0xf
    v_and_b32_dpp v35, v12, v7 row_newbcast:0 row_mask:0xf bank_mask:0xf
    v_and_b32_dpp v36, v12, v4 row_newbcast:1 row_mask:0xf bank_mask:0xf
    v_and_b32_dpp v37, v12, v5 row_newbcast:1 row_mask:0xf bank_mask:0xf
    v_and_b32_dpp v38, v12, v6 row_newbcast:1 row_mask:0xf bank_mask:0xf
    v_and_b32_dpp v39, v12, v7 row_newbcast:1 row_mask:0xf bank_mask:0xf
    v_mfma_f32_16x16x32_bf16 v[24:27], v[64:67], v[32:35], 0
    v_and_b32_dpp v40, v12, v4 row_newbcast:2 row_mask:0xf bank_mask:0xf
    v_and_b32_dpp v41, v12, v5 row_newbcast:2 row_mask:0xf bank_mask:0xf
    v_and_b32_dpp v42, v12, v6 row_newbcast:2 row_mask:0xf bank_mask:0xf
    v_and_b32_dpp v43, v12, v7 row_newbcast:2 row_mask:0xf bank_mask:0xf
    v_mfma_f32_16x16x32_bf16 v[24:27], v[68:71], v[36:39], v[24:27]
    v_and_b32_dpp v44, v12, v4 row_newbcast:3 row_mask:0xf bank_mask:0xf
    v_and_b32_dpp v45, v12, v5 row_newbcast:3 row_mask:0xf bank_mask:0xf
    v_and_b32_dpp v46, v12, v6 row_newbcast:3 row_mask:0xf bank_mask:0xf
    v_and_b32_dpp v47, v12, v7 row_newbcast:3 row_mask:0xf bank_mask:0xf
    v_mfma_f32_16x16x32_bf16 v[24:27], v[72:75], v[40:43], v[24:27]
    v_and_b32_dpp v48, v12, v4 row_newbcast:4 row_mask:0xf bank_mask:0xf
    v_and_b32_dpp v49, v12, v5 row_newbcast:4 row_mask:0xf bank_mask:0xf
    v_and_b32_dpp v50, v12, v6 row_newbcast:4 row_mask:0xf bank_mask:0xf
    v_and_b32_dpp v51, v12, v7 row_newbcast:4 row_mask:0xf bank_mask:0xf
    v_mfma_f32_16x16x32_bf16 v[24:27], v[76:79], v[44:47], v[24:27]
    v_and_b32_dpp v52, v12, v4 row_newbcast:5 row_mask:0xf bank_mask:0xf
    v_and_b32_dpp v53, v12, v5 row_newbcast:5 row_mask:0xf bank_mask:0xf
    v_and_b32_dpp v54, v12, v6 row_newbcast:5 row_mask:0xf bank_mask:0xf
    v_and_b32_dpp v55, v12, v7 row_newbcast:5 row_mask:0xf bank_mask:0xf
    v_mfma_f32_16x16x32_bf16 v[24:27], v[80:83], v[48:51], v[24:27]
    v_and_b32_dpp v56, v12, v4 row_newbcast:6 row_mask:0xf bank_mask:0xf
    v_and_b32_dpp v57, v12, v5 row_newbcast:6 row_mask:0xf bank_mask:0xf
    v_and_b32_dpp v58, v12, v6 row_newbcast:6 row_mask:0xf bank_mask:0xf
    v_and_b32_dpp v59, v12, v7 row_newbcast:6 row_mask:0xf bank_mask:0xf
    v_mfma_f32_16x16x32_bf16 v[24:27], v[84:87], v[52:55], v[24:27]
    v_and_b32_dpp v60, v12, v4 row_newbcast:7 row_mask:0xf bank_mask:0xf
    v_and_b32_dpp v61, v12, v5 row_newbcast:7 row_mask:0xf bank_mask:0xf
    v_and_b32_dpp v62, v12, v6 row_newbcast:7 row_mask:0xf bank_mask:0xf
    v_and_b32_dpp v63, v12, v7 row_newbcast:7 row_mask:0xf bank_mask:0xf
    v_mfma_f32_16x16x32_bf16 v[24:27], v[88:91], v[56:59], v[24:27]
    v_and_b32_dpp v128, v12, v4 row_newbcast:8 row_mask:0xf bank_mask:0xf
    v_and_b32_dpp v129, v12, v5 row_newbcast:8 row_mask:0xf bank_mask:0xf
    v_and_b32_dpp v130, v12, v6 row_newbcast:8 row_mask:0xf bank_mask:0xf
    v_and_b32_dpp v131, v12, v7 row_newbcast:8 row_mask:0xf bank_mask:0xf
    v_mfma_f32_16x16x32_bf16 v[24:27], v[92:95], v[60:63], v[24:27]
    v_and_b32_dpp v132, v12, v4 row_newbcast:9 row_mask:0xf bank_mask:0xf
    v_and_b32_dpp v133, v12, v5 row_newbcast:9 row_mask:0xf bank_mask:0xf
    v_and_b32_dpp v134, v12, v6 row_newbcast:9 row_mask:0xf bank_mask:0xf
    v_and_b32_dpp v135, v12, v7 row_newbcast:9 row_mask:0xf bank_mask:0xf
    v_mfma_f32_16x16x32_bf16 v[24:27], v[96:99], v[128:131], v[24:27]
    v_and_b32_dpp v136, v12, v4 row_newbcast:10 row_mask:0xf bank_mask:0xf
    v_and_b32_dpp v137, v12, v5 row_newbcast:10 row_mask:0xf bank_mask:0xf
    v_and_b32_dpp v138, v12, v6 row_newbcast:10 row_mask:0xf bank_mask:0xf
    v_and_b32_dpp v139, v12, v7 row_newbcast:10 row_mask:0xf bank_mask:0xf
    v_mfma_f32_16x16x32_bf16 v[24:27], v[100:103], v[132:135], v[24:27]
    v_and_b32_dpp v140, v12, v4 row_newbcast:11 row_mask:0xf bank_mask:0xf
    v_and_b32_dpp v141, v12, v5 row_newbcast:11 row_mask:0xf bank_mask:0xf
    v_and_b32_dpp v142, v12, v6 row_newbcast:11 row_mask:0xf bank_mask:0xf
    v_and_b32_dpp v143, v12, v7 row_newbcast:11 row_mask:0xf bank_mask:0xf
    v_mfma_f32_16x16x32_bf16 v[24:27], v[104:107], v[136:139], v[24:27]
    v_and_b32_dpp v144, v12, v4 row_newbcast:12 row_mask:0xf bank_mask:0xf
    v_and_b32_dpp v145, v12, v5 row_newbcast:12 row_mask:0xf bank_mask:0xf
    v_and_b32_dpp v146, v12, v6 row_newbcast:12 row_mask:0xf bank_mask:0xf
    v_and_b32_dpp v147, v12, v7 row_newbcast:12 row_mask:0xf bank_mask:0xf
    v_mfma_f32_16x16x32_bf16 v[24:27], v[108:111], v[140:143], v[24:27]
    v_and_b32_dpp v148, v12, v4 row_newbcast:13 row_mask:0xf bank_mask:0xf
    v_and_b32_dpp v149, v12, v5 row_newbcast:13 row_mask:0xf bank_mask:0xf
    v_and_b32_dpp v150, v12, v6 row_newbcast:13 row_mask:0xf bank_mask:0xf
    v_and_b32_dpp v151, v12, v7 row_newbcast:13 row_mask:0xf bank_mask:0xf
    v_mfma_f32_16x16x32_bf16 v[24:27], v[112:115], v[144:147], v[24:27]
    v_and_b32_dpp v152, v12, v4 row_newbcast:14 row_mask:0xf bank_mask:0xf
    v_and_b32_dpp v153, v12, v5 row_newbcast:14 row_mask:0xf bank_mask:0xf
    v_and_b32_dpp v154, v12, v6 row_newbcast:14 row_mask:0xf bank_mask:0xf
    v_and_b32_dpp v155, v12, v7 row_newbcast:14 row_mask:0xf bank_mask:0xf
    v_mfma_f32_16x16x32_bf16 v[24:27], v[116:119], v[148:151], v[24:27]
    v_and_b32_dpp v156, v12, v4 row_newbcast:15 row_mask:0xf bank_mask:0xf
    v_and_b32_dpp v157, v12, v5 row_newbcast:15 row_mask:0xf bank_mask:0xf
    v_and_b32_dpp v158, v12, v6 row_newbcast:15 row_mask:0xf bank_mask:0xf
    v_and_b32_dpp v159, v12, v7 row_newbcast:15 row_mask:0xf bank_mask:0xf
    v_mfma_f32_16x16x32_bf16 v[24:27], v[120:123], v[152:155], v[24:27]
    s_nop 0
    v_mfma_f32_16x16x32_bf16 v[24:27], v[124:127], v[156:159], v[24:27]
    s_mov_b32 exec_lo, 0x55555555
    s_mov_b32 exec_hi, 0x55555555
    s_nop 5
    ds_write_b128 v22, v[24:27] offset:2304
    s_waitcnt lgkmcnt(0)
    s_mov_b64 exec, -1
    s_cmp_ge_u32 s3, s20
    s_barrier
    s_cbranch_scc1 L_fin
    ds_read_b128 v[32:35], v23 offset:2304
    s_waitcnt lgkmcnt(0)
    v_add_f32_dpp v32, v32, v32 quad_perm:[1,0,3,2] row_mask:0xf bank_mask:0xf
    v_add_f32_dpp v33, v33, v33 quad_perm:[1,0,3,2] row_mask:0xf bank_mask:0xf
    v_add_f32_dpp v34, v34, v34 quad_perm:[1,0,3,2] row_mask:0xf bank_mask:0xf
    v_add_f32_dpp v35, v35, v35 quad_perm:[1,0,3,2] row_mask:0xf bank_mask:0xf
    v_add_f32_dpp v32, v32, v32 quad_perm:[2,3,0,1] row_mask:0xf bank_mask:0xf
    v_add_f32_dpp v33, v33, v33 quad_perm:[2,3,0,1] row_mask:0xf bank_mask:0xf
    v_add_f32_dpp v34, v34, v34 quad_perm:[2,3,0,1] row_mask:0xf bank_mask:0xf
    v_add_f32_dpp v35, v35, v35 quad_perm:[2,3,0,1] row_mask:0xf bank_mask:0xf
    v_add_f32_dpp v32, v32, v32 row_half_mirror row_mask:0xf bank_mask:0xf
    v_add_f32_dpp v33, v33, v33 row_half_mirror row_mask:0xf bank_mask:0xf
    v_add_f32_dpp v34, v34, v34 row_half_mirror row_mask:0xf bank_mask:0xf
    v_add_f32_dpp v35, v35, v35 row_half_mirror row_mask:0xf bank_mask:0xf
    s_mov_b32 exec_lo, 0x01010101
    s_mov_b32 exec_hi, 0x01010101
    v_and_or_b32 v32, v32, s79, v8
    v_and_or_b32 v33, v33, s79, v9
    v_and_or_b32 v34, v34, s79, v10
    v_and_or_b32 v35, v35, s79, v11
    buffer_store_dwordx4 v[32:35], v17, s[40:43], s15 offen sc1
    s_endpgm
L_Qonly:
L_Opub:
    s_barrier
    s_cmp_lg_u32 s3, 8
    s_cbranch_scc1 L_Q3O
    ds_read2st64_b32 v[32:33], v19 offset0:0 offset1:1
    ds_read2st64_b32 v[34:35], v19 offset0:2 offset1:3
    ds_read2st64_b32 v[36:37], v19 offset0:4 offset1:5
    ds_read2st64_b32 v[38:39], v19 offset0:6 offset1:7
    ds_read_b32 v40, v19 offset:2048
    s_waitcnt lgkmcnt(3)
    v_pk_add_f32 v[32:33], v[32:33], v[34:35]
    s_waitcnt lgkmcnt(1)
    v_pk_add_f32 v[36:37], v[36:37], v[38:39]
    v_pk_add_f32 v[32:33], v[32:33], v[36:37]
    s_waitcnt lgkmcnt(0)
    v_add_f32 v32, v32, v40
    v_add_f32 v32, v32, v33
    v_mov_b32 v33, s76
    v_lshlrev_b32 v44, 3, v1
    buffer_store_dwordx2 v[32:33], v44, s[40:43], s10 offen
    buffer_store_dwordx2 v[32:33], v44, s[40:43], s11 offen sc1
L_Q3O:
    s_barrier
    s_endpgm
L_end:
    s_endpgm

.section .rodata,"a"
.p2align 6
.amdhsa_kernel sequential_preLN__sliding_block_cached__dense_activation_silu__decode_kernel
  .amdhsa_next_free_vgpr 168
  .amdhsa_next_free_sgpr 102
  .amdhsa_accum_offset 168
  .amdhsa_group_segment_fixed_size 0
  .amdhsa_kernarg_size 88
  .amdhsa_user_sgpr_count 2
  .amdhsa_user_sgpr_kernarg_segment_ptr 1
  .amdhsa_system_sgpr_workgroup_id_x 1
  .amdhsa_float_denorm_mode_32 3
.end_amdhsa_kernel
```
